```python
import torch

def _softmax(x, axis=-1):
    return torch.softmax(x, dim=axis)
def _gelu(x):
    return torch.nn.functional.gelu(x, approximate="tanh")
def _silu(x):
    return torch.nn.functional.silu(x)
def _sigmoid(x):
    return torch.sigmoid(x)
def _layernorm(x, axis=-1, eps=1e-5):
    m = x.mean(dim=axis, keepdim=True)
    v = x.var(dim=axis, keepdim=True, unbiased=False)
    return (x - m) / torch.sqrt(v + eps)
def _scatter_add(tgt, idx, src, axis=0):
    return tgt.clone().index_add_(axis, idx, src)
def _segment_sum(src, seg, n):
    out = torch.zeros((n,) + src.shape[1:], dtype=src.dtype)
    return out.index_add_(0, seg, src)
def _pad(x, pw):
    flat = tuple(v for pair in reversed(pw) for v in pair)
    return torch.nn.functional.pad(x, flat)

kernel_name = 'gather_scatter__hybrid_graph_tf_graphgps__graph'

def setup_inputs():

    _w = (lambda a: (lambda t: t.to(torch.bfloat16) if t.is_floating_point() else t)(torch.as_tensor(a)))
    N, deg, D = 12500, 32, 128
    E = N * deg
    src = (lambda lo, hi, *s: torch.randint(lo, hi, s))(0, N, E).to(torch.int64)
    dst = (lambda lo, hi, *s: torch.randint(lo, hi, s))(0, N, E).to(torch.int64)
    deg_cnt = torch.bincount(dst, minlength=N).to(float) + 1.0
    sc = 1.0 / float(D) ** 0.5
    return {
        "x": _w((lambda *s: torch.randn(*s, dtype=torch.bfloat16) * 0.05)(N, D)),
        "src": _w(src),
        "dst": _w(dst),
        "deg_inv": _w((1.0 / deg_cnt).to(float)),
        "w_msg": _w((lambda *s: torch.randn(*s, dtype=torch.bfloat16) * 0.4)(D, D) * sc),
        "wq": _w((lambda *s: torch.randn(*s, dtype=torch.bfloat16) * 1.6)(D, D) * sc),
        "wk": _w((lambda *s: torch.randn(*s, dtype=torch.bfloat16) * 1.6)(D, D) * sc),
        "wv": _w((lambda *s: torch.randn(*s, dtype=torch.bfloat16) * 0.2)(D, D) * sc),
        "w_out": _w((lambda *s: torch.randn(*s, dtype=torch.bfloat16) * 0.2)(D, D) * sc),
    }

def reference(x, src, dst, deg_inv, w_msg, wq, wk, wv, w_out):
    N, D = x.shape[0], x.shape[1]
    h = _layernorm(x, axis=-1)
    m_e = torch.einsum('nd,de->ne', h, w_msg)
    h_local = _segment_sum(m_e[src], dst, N) * deg_inv[:, None]
    q = torch.einsum('nd,de->ne', h, wq)
    k = torch.einsum('nd,de->ne', h, wk)
    v = torch.einsum('nd,de->ne', h, wv)
    logits = torch.einsum('id,jd->ij', q, k) / (float(D) ** 0.5)
    attn = _softmax(logits, axis=-1)
    h_global = torch.einsum('ij,jd->id', attn, v)
    y = torch.einsum('nd,de->ne', h_local + h_global, w_out)
    return x + y
```

```asm
; @launch kernel=gps_prep_kernel grid=(256,1,1) block=(320,1,1) lds=65536
; @launch kernel=gps_attn_kernel grid=(249,1,1) block=(256,1,1) lds=162880
.amdgcn_target "amdgcn-amd-amdhsa--gfx950"
.text
.globl gps_prep_kernel
.p2align 8
.type gps_prep_kernel,@function
gps_prep_kernel:
  v_lshrrev_b32 v7, 6, v0
  s_cmp_lt_u32 s2, 60
  v_readfirstlane_b32 s33, v7
  s_cbranch_scc1 Lk1_bin
  s_cmp_lt_u32 s2, 256
  s_cselect_b32 s3, 4, 0
  s_cmp_lt_u32 s33, s3
  s_cbranch_scc1 Lk1_ln
  s_endpgm
Lk1_bin:
  s_load_dwordx4 s[4:7], s[0:1], 8
  s_load_dwordx2 s[12:13], s[0:1], 88
Lk1_pfb:
  v_lshlrev_b32 v1, 4, v0
  v_lshrrev_b32 v7, 6, v0
  v_mov_b64 v[8:9], 0
  v_mov_b64 v[10:11], 0
  v_readfirstlane_b32 s33, v7
  ds_write_b128 v1, v[8:11]
  s_mul_i32 s34, s2, 26672
  v_mov_b32 v12, 0xffff
  v_mov_b32 v13, v12
  v_mov_b32 v14, v12
  v_mov_b32 v15, v12
  s_waitcnt lgkmcnt(0)
  s_mov_b32 s20, s6
  s_and_b32 s21, s7, 0xffff
  s_mov_b32 s22, 1600000
  s_mov_b32 s23, 0x20000
  s_add_u32 s35, s34, 0
  buffer_load_dwordx4 v[16:19], v1, s[20:23], s35 offen
  s_add_u32 s35, s34, 5120
  buffer_load_dwordx4 v[20:23], v1, s[20:23], s35 offen
  s_add_u32 s35, s34, 10240
  buffer_load_dwordx4 v[24:27], v1, s[20:23], s35 offen
  s_add_u32 s35, s34, 15360
  buffer_load_dwordx4 v[28:31], v1, s[20:23], s35 offen
  s_add_u32 s35, s34, 20480
  buffer_load_dwordx4 v[32:35], v1, s[20:23], s35 offen
  s_add_u32 s35, s34, 25600
  buffer_load_dwordx4 v[36:39], v1, s[20:23], s35 offen
  s_mov_b32 s16, s4
  s_and_b32 s17, s5, 0xffff
  s_mov_b32 s18, 1600000
  s_mov_b32 s19, 0x20000
  s_add_u32 s35, s34, 0
  buffer_load_dwordx4 v[44:47], v1, s[16:19], s35 offen
  s_add_u32 s35, s34, 5120
  buffer_load_dwordx4 v[48:51], v1, s[16:19], s35 offen
  s_add_u32 s35, s34, 10240
  buffer_load_dwordx4 v[52:55], v1, s[16:19], s35 offen
  s_add_u32 s35, s34, 15360
  buffer_load_dwordx4 v[56:59], v1, s[16:19], s35 offen
  s_add_u32 s35, s34, 20480
  buffer_load_dwordx4 v[60:63], v1, s[16:19], s35 offen
  s_add_u32 s35, s34, 25600
  buffer_load_dwordx4 v[64:67], v1, s[16:19], s35 offen
  s_mov_b32 s28, s12
  s_and_b32 s29, s13, 0xffff
  s_mov_b32 s30, 67108864
  s_mov_b32 s31, 0x20000
  ds_write_b128 v1, v[12:15] offset:8192
  ds_write_b128 v1, v[12:15] offset:13312
  ds_write_b128 v1, v[12:15] offset:18432
  ds_write_b128 v1, v[12:15] offset:23552
  ds_write_b128 v1, v[12:15] offset:28672
  ds_write_b128 v1, v[12:15] offset:33792
  ds_write_b128 v1, v[12:15] offset:38912
  ds_write_b128 v1, v[12:15] offset:44032
  v_and_b32 v2, 0xf0, v1
  s_lshl_b32 s35, s2, 8
  s_add_u32 s35, s35, 59768832
  s_add_u32 s36, s35, 65536
  v_and_b32 v4, 63, v0
  v_lshlrev_b32 v4, 2, v4
  v_add_u32 v4, 3136, v4
  v_lshlrev_b32 v3, 2, v0
  s_mov_b32 s43, 0x10000
  s_movk_i32 s44, 3132
  s_mov_b32 s45, -4
  s_mul_i32 s46, s2, 6668
  s_sub_u32 s46, 400000, s46
  s_min_u32 s46, s46, 6668
  s_cmp_lg_u32 s33, 0
  s_cbranch_scc1 Lk1_b0
  buffer_store_dwordx4 v[8:11], v2, s[28:31], s35 offen sc1
  buffer_store_dwordx4 v[12:15], v2, s[28:31], s36 offen sc1
  v_and_b32 v2, 0x1f0, v1
  s_lshl_b32 s35, s2, 9
  s_add_u32 s35, s35, 59899904
  buffer_store_dwordx4 v[8:11], v2, s[28:31], s35 offen sc1
Lk1_b0:
  v_mov_b32 v2, 1
  s_waitcnt lgkmcnt(0)
  s_barrier
  s_waitcnt vmcnt(11)
  v_lshrrev_b32 v100, 2, v16
  v_and_b32 v100, s45, v100
  v_min_u32 v100, s44, v100
  ds_add_rtn_u32 v72, v100, v2
  v_lshrrev_b32 v101, 2, v17
  v_and_b32 v101, s45, v101
  v_min_u32 v101, s44, v101
  ds_add_rtn_u32 v73, v101, v2
  v_lshrrev_b32 v102, 2, v18
  v_and_b32 v102, s45, v102
  v_min_u32 v102, s44, v102
  ds_add_rtn_u32 v74, v102, v2
  v_lshrrev_b32 v103, 2, v19
  v_and_b32 v103, s45, v103
  v_min_u32 v103, s44, v103
  ds_add_rtn_u32 v75, v103, v2
  s_waitcnt vmcnt(10)
  v_lshrrev_b32 v104, 2, v20
  v_and_b32 v104, s45, v104
  v_min_u32 v104, s44, v104
  ds_add_rtn_u32 v76, v104, v2
  v_lshrrev_b32 v105, 2, v21
  v_and_b32 v105, s45, v105
  v_min_u32 v105, s44, v105
  ds_add_rtn_u32 v77, v105, v2
  v_lshrrev_b32 v106, 2, v22
  v_and_b32 v106, s45, v106
  v_min_u32 v106, s44, v106
  ds_add_rtn_u32 v78, v106, v2
  v_lshrrev_b32 v107, 2, v23
  v_and_b32 v107, s45, v107
  v_min_u32 v107, s44, v107
  ds_add_rtn_u32 v79, v107, v2
  s_waitcnt vmcnt(9)
  v_lshrrev_b32 v108, 2, v24
  v_and_b32 v108, s45, v108
  v_min_u32 v108, s44, v108
  ds_add_rtn_u32 v80, v108, v2
  v_lshrrev_b32 v109, 2, v25
  v_and_b32 v109, s45, v109
  v_min_u32 v109, s44, v109
  ds_add_rtn_u32 v81, v109, v2
  v_lshrrev_b32 v110, 2, v26
  v_and_b32 v110, s45, v110
  v_min_u32 v110, s44, v110
  ds_add_rtn_u32 v82, v110, v2
  v_lshrrev_b32 v111, 2, v27
  v_and_b32 v111, s45, v111
  v_min_u32 v111, s44, v111
  ds_add_rtn_u32 v83, v111, v2
  s_waitcnt vmcnt(8)
  v_lshrrev_b32 v112, 2, v28
  v_and_b32 v112, s45, v112
  v_min_u32 v112, s44, v112
  ds_add_rtn_u32 v84, v112, v2
  v_lshrrev_b32 v113, 2, v29
  v_and_b32 v113, s45, v113
  v_min_u32 v113, s44, v113
  ds_add_rtn_u32 v85, v113, v2
  v_lshrrev_b32 v114, 2, v30
  v_and_b32 v114, s45, v114
  v_min_u32 v114, s44, v114
  ds_add_rtn_u32 v86, v114, v2
  v_lshrrev_b32 v115, 2, v31
  v_and_b32 v115, s45, v115
  v_min_u32 v115, s44, v115
  ds_add_rtn_u32 v87, v115, v2
  s_waitcnt vmcnt(7)
  v_lshrrev_b32 v116, 2, v32
  v_and_b32 v116, s45, v116
  v_min_u32 v116, s44, v116
  ds_add_rtn_u32 v88, v116, v2
  v_lshrrev_b32 v117, 2, v33
  v_and_b32 v117, s45, v117
  v_min_u32 v117, s44, v117
  ds_add_rtn_u32 v89, v117, v2
  v_lshrrev_b32 v118, 2, v34
  v_and_b32 v118, s45, v118
  v_min_u32 v118, s44, v118
  ds_add_rtn_u32 v90, v118, v2
  v_lshrrev_b32 v119, 2, v35
  v_and_b32 v119, s45, v119
  v_min_u32 v119, s44, v119
  ds_add_rtn_u32 v91, v119, v2
  s_waitcnt vmcnt(6)
  v_lshrrev_b32 v120, 2, v36
  v_and_b32 v120, s45, v120
  v_min_u32 v120, s44, v120
  s_sub_u32 s47, s46, 6400
  v_cmp_gt_u32 vcc, s47, v3
  s_nop 1
  v_cndmask_b32 v120, v4, v120, vcc
  ds_add_rtn_u32 v92, v120, v2
  v_lshrrev_b32 v121, 2, v37
  v_and_b32 v121, s45, v121
  v_min_u32 v121, s44, v121
  s_sub_u32 s47, s46, 6401
  v_cmp_gt_u32 vcc, s47, v3
  s_nop 1
  v_cndmask_b32 v121, v4, v121, vcc
  ds_add_rtn_u32 v93, v121, v2
  v_lshrrev_b32 v122, 2, v38
  v_and_b32 v122, s45, v122
  v_min_u32 v122, s44, v122
  s_sub_u32 s47, s46, 6402
  v_cmp_gt_u32 vcc, s47, v3
  s_nop 1
  v_cndmask_b32 v122, v4, v122, vcc
  ds_add_rtn_u32 v94, v122, v2
  v_lshrrev_b32 v123, 2, v39
  v_and_b32 v123, s45, v123
  v_min_u32 v123, s44, v123
  s_sub_u32 s47, s46, 6403
  v_cmp_gt_u32 vcc, s47, v3
  s_nop 1
  v_cndmask_b32 v123, v4, v123, vcc
  ds_add_rtn_u32 v95, v123, v2
  s_waitcnt vmcnt(0)
  v_and_b32 v16, 15, v16
  v_lshl_or_b32 v16, s43, v16, v44
  v_and_b32 v17, 15, v17
  v_lshl_or_b32 v17, s43, v17, v45
  v_and_b32 v18, 15, v18
  v_lshl_or_b32 v18, s43, v18, v46
  v_and_b32 v19, 15, v19
  v_lshl_or_b32 v19, s43, v19, v47
  v_and_b32 v20, 15, v20
  v_lshl_or_b32 v20, s43, v20, v48
  v_and_b32 v21, 15, v21
  v_lshl_or_b32 v21, s43, v21, v49
  v_and_b32 v22, 15, v22
  v_lshl_or_b32 v22, s43, v22, v50
  v_and_b32 v23, 15, v23
  v_lshl_or_b32 v23, s43, v23, v51
  v_and_b32 v24, 15, v24
  v_lshl_or_b32 v24, s43, v24, v52
  v_and_b32 v25, 15, v25
  v_lshl_or_b32 v25, s43, v25, v53
  v_and_b32 v26, 15, v26
  v_lshl_or_b32 v26, s43, v26, v54
  v_and_b32 v27, 15, v27
  v_lshl_or_b32 v27, s43, v27, v55
  v_and_b32 v28, 15, v28
  v_lshl_or_b32 v28, s43, v28, v56
  v_and_b32 v29, 15, v29
  v_lshl_or_b32 v29, s43, v29, v57
  v_and_b32 v30, 15, v30
  v_lshl_or_b32 v30, s43, v30, v58
  v_and_b32 v31, 15, v31
  v_lshl_or_b32 v31, s43, v31, v59
  v_and_b32 v32, 15, v32
  v_lshl_or_b32 v32, s43, v32, v60
  v_and_b32 v33, 15, v33
  v_lshl_or_b32 v33, s43, v33, v61
  v_and_b32 v34, 15, v34
  v_lshl_or_b32 v34, s43, v34, v62
  v_and_b32 v35, 15, v35
  v_lshl_or_b32 v35, s43, v35, v63
  v_and_b32 v36, 15, v36
  v_lshl_or_b32 v36, s43, v36, v64
  v_and_b32 v37, 15, v37
  v_lshl_or_b32 v37, s43, v37, v65
  v_and_b32 v38, 15, v38
  v_lshl_or_b32 v38, s43, v38, v66
  v_and_b32 v39, 15, v39
  v_lshl_or_b32 v39, s43, v39, v67
  s_waitcnt lgkmcnt(0)
  s_barrier
  ds_read_b128 v[8:11], v1
  s_lshl_b32 s37, s33, 2
  s_add_u32 s37, s37, 56560
  v_mov_b32 v6, s37
  s_waitcnt lgkmcnt(0)
  v_add_u32 v8, 3, v8
  v_add_u32 v9, 3, v9
  v_add_u32 v10, 3, v10
  v_add_u32 v11, 3, v11
  v_and_b32 v8, -4, v8
  v_and_b32 v9, -4, v9
  v_and_b32 v10, -4, v10
  v_and_b32 v11, -4, v11
  v_add_u32 v13, v8, v9
  v_add_u32 v14, v13, v10
  v_add_u32 v15, v14, v11
  v_mov_b32 v5, v15
  s_nop 1
  v_add_u32_dpp v5, v5, v5 row_shr:1 row_mask:0xf bank_mask:0xf
  s_nop 1
  v_add_u32_dpp v5, v5, v5 row_shr:2 row_mask:0xf bank_mask:0xf
  s_nop 1
  v_add_u32_dpp v5, v5, v5 row_shr:4 row_mask:0xf bank_mask:0xf
  s_nop 1
  v_add_u32_dpp v5, v5, v5 row_shr:8 row_mask:0xf bank_mask:0xf
  s_nop 1
  v_add_u32_dpp v5, v5, v5 row_bcast:15 row_mask:0xa bank_mask:0xf
  s_nop 1
  v_add_u32_dpp v5, v5, v5 row_bcast:31 row_mask:0xc bank_mask:0xf
  s_nop 0
  v_readlane_b32 s36, v5, 63
  s_nop 1
  v_mov_b32 v4, s36
  ds_write_b32 v6, v4
  v_mov_b32 v6, 56560
  s_cmp_gt_u32 s33, 0
  s_cselect_b32 s38, -1, 0
  s_cmp_gt_u32 s33, 1
  s_cselect_b32 s39, -1, 0
  s_cmp_gt_u32 s33, 2
  s_cselect_b32 s40, -1, 0
  v_sub_u32 v5, v5, v15
  s_waitcnt lgkmcnt(0)
  s_barrier
  ds_read_b128 v[128:131], v6
  s_lshl_b32 s41, s2, 13
  s_add_u32 s41, s41, 15728640
  s_waitcnt lgkmcnt(0)
  v_and_b32 v128, s38, v128
  v_and_b32 v129, s39, v129
  v_and_b32 v130, s40, v130
  v_add3_u32 v5, v5, v128, v129
  v_add_u32 v132, v5, v130
  v_add_u32 v133, v132, v8
  v_add_u32 v134, v132, v13
  v_add_u32 v135, v132, v14
  ds_write_b128 v1, v[132:135]
  buffer_store_dwordx4 v[132:135], v1, s[28:31], s41 offen sc1
  s_waitcnt lgkmcnt(0)
  s_barrier
  ds_read_b32 v100, v100
  ds_read_b32 v101, v101
  ds_read_b32 v102, v102
  ds_read_b32 v103, v103
  ds_read_b32 v104, v104
  ds_read_b32 v105, v105
  ds_read_b32 v106, v106
  ds_read_b32 v107, v107
  ds_read_b32 v108, v108
  ds_read_b32 v109, v109
  ds_read_b32 v110, v110
  ds_read_b32 v111, v111
  ds_read_b32 v112, v112
  ds_read_b32 v113, v113
  ds_read_b32 v114, v114
  ds_read_b32 v115, v115
  ds_read_b32 v116, v116
  ds_read_b32 v117, v117
  ds_read_b32 v118, v118
  ds_read_b32 v119, v119
  ds_read_b32 v120, v120
  ds_read_b32 v121, v121
  ds_read_b32 v122, v122
  ds_read_b32 v123, v123
  s_waitcnt lgkmcnt(15)
  v_add_lshl_u32 v100, v100, v72, 2
  ds_write_b32 v100, v16 offset:8192
  v_add_lshl_u32 v101, v101, v73, 2
  ds_write_b32 v101, v17 offset:8192
  v_add_lshl_u32 v102, v102, v74, 2
  ds_write_b32 v102, v18 offset:8192
  v_add_lshl_u32 v103, v103, v75, 2
  ds_write_b32 v103, v19 offset:8192
  v_add_lshl_u32 v104, v104, v76, 2
  ds_write_b32 v104, v20 offset:8192
  v_add_lshl_u32 v105, v105, v77, 2
  ds_write_b32 v105, v21 offset:8192
  v_add_lshl_u32 v106, v106, v78, 2
  ds_write_b32 v106, v22 offset:8192
  v_add_lshl_u32 v107, v107, v79, 2
  ds_write_b32 v107, v23 offset:8192
  v_add_lshl_u32 v108, v108, v80, 2
  ds_write_b32 v108, v24 offset:8192
  s_waitcnt lgkmcnt(15)
  v_add_lshl_u32 v109, v109, v81, 2
  ds_write_b32 v109, v25 offset:8192
  v_add_lshl_u32 v110, v110, v82, 2
  ds_write_b32 v110, v26 offset:8192
  v_add_lshl_u32 v111, v111, v83, 2
  ds_write_b32 v111, v27 offset:8192
  v_add_lshl_u32 v112, v112, v84, 2
  ds_write_b32 v112, v28 offset:8192
  v_add_lshl_u32 v113, v113, v85, 2
  ds_write_b32 v113, v29 offset:8192
  v_add_lshl_u32 v114, v114, v86, 2
  ds_write_b32 v114, v30 offset:8192
  v_add_lshl_u32 v115, v115, v87, 2
  ds_write_b32 v115, v31 offset:8192
  v_add_lshl_u32 v116, v116, v88, 2
  ds_write_b32 v116, v32 offset:8192
  v_add_lshl_u32 v117, v117, v89, 2
  ds_write_b32 v117, v33 offset:8192
  s_waitcnt lgkmcnt(15)
  v_add_lshl_u32 v118, v118, v90, 2
  ds_write_b32 v118, v34 offset:8192
  v_add_lshl_u32 v119, v119, v91, 2
  ds_write_b32 v119, v35 offset:8192
  v_add_lshl_u32 v120, v120, v92, 2
  ds_write_b32 v120, v36 offset:8192
  v_add_lshl_u32 v121, v121, v93, 2
  ds_write_b32 v121, v37 offset:8192
  v_add_lshl_u32 v122, v122, v94, 2
  ds_write_b32 v122, v38 offset:8192
  v_add_lshl_u32 v123, v123, v95, 2
  ds_write_b32 v123, v39 offset:8192
  s_mul_i32 s42, s2, 40960
  s_add_u32 s42, s42, 12582912
  s_waitcnt lgkmcnt(0)
  s_barrier
  ds_read_b128 v[44:47], v1 offset:8192
  ds_read_b128 v[48:51], v1 offset:13312
  ds_read_b128 v[52:55], v1 offset:18432
  ds_read_b128 v[56:59], v1 offset:23552
  ds_read_b128 v[60:63], v1 offset:28672
  ds_read_b128 v[64:67], v1 offset:33792
  ds_read_b128 v[68:71], v1 offset:38912
  ds_read_b128 v[72:75], v1 offset:44032
  s_add_u32 s35, s42, 0
  s_waitcnt lgkmcnt(7)
  buffer_store_dwordx4 v[44:47], v1, s[28:31], s35 offen sc1
  s_add_u32 s35, s42, 5120
  s_waitcnt lgkmcnt(6)
  buffer_store_dwordx4 v[48:51], v1, s[28:31], s35 offen sc1
  s_add_u32 s35, s42, 10240
  s_waitcnt lgkmcnt(5)
  buffer_store_dwordx4 v[52:55], v1, s[28:31], s35 offen sc1
  s_add_u32 s35, s42, 15360
  s_waitcnt lgkmcnt(4)
  buffer_store_dwordx4 v[56:59], v1, s[28:31], s35 offen sc1
  s_add_u32 s35, s42, 20480
  s_waitcnt lgkmcnt(3)
  buffer_store_dwordx4 v[60:63], v1, s[28:31], s35 offen sc1
  s_add_u32 s35, s42, 25600
  s_waitcnt lgkmcnt(2)
  buffer_store_dwordx4 v[64:67], v1, s[28:31], s35 offen sc1
  s_add_u32 s35, s42, 30720
  s_waitcnt lgkmcnt(1)
  buffer_store_dwordx4 v[68:71], v1, s[28:31], s35 offen sc1
  s_add_u32 s35, s42, 35840
  s_waitcnt lgkmcnt(0)
  buffer_store_dwordx4 v[72:75], v1, s[28:31], s35 offen sc1
  s_endpgm
Lk1_ln:
  s_load_dwordx2 s[4:5], s[0:1], 0
  s_load_dwordx4 s[8:11], s[0:1], 40
  s_load_dwordx2 s[12:13], s[0:1], 88
  v_and_b32 v1, 63, v0
  s_getpc_b64 s[14:15]
Lpf0:
  s_add_u32 s14, s14, Lk1_pfstart-Lpf0
  s_addc_u32 s15, s15, 0
  v_lshlrev_b32 v198, 7, v1
  global_load_dword v199, v198, s[14:15]
Lk1_pfstart:
  v_lshrrev_b32 v7, 6, v0
  v_lshrrev_b32 v2, 4, v1
  v_and_b32 v3, 15, v1
  v_readfirstlane_b32 s33, v7
  s_sub_u32 s34, s2, 60
  s_lshl_b32 s34, s34, 2
  v_lshlrev_b32 v4, 8, v3
  v_lshl_add_u32 v4, v2, 4, v4
  s_add_u32 s34, s34, s33
  s_lshl_b32 s35, s34, 12
  s_waitcnt lgkmcnt(0)
  s_mov_b32 s16, s4
  s_and_b32 s17, s5, 0xffff
  s_mov_b32 s18, 3200000
  s_mov_b32 s19, 0x20000
  buffer_load_dwordx4 v[8:11], v4, s[16:19], s35 offen offset:0
  buffer_load_dwordx4 v[12:15], v4, s[16:19], s35 offen offset:64
  buffer_load_dwordx4 v[16:19], v4, s[16:19], s35 offen offset:128
  buffer_load_dwordx4 v[20:23], v4, s[16:19], s35 offen offset:192
  s_mov_b32 s20, s8
  s_and_b32 s21, s9, 0xffff
  s_mov_b32 s22, 32768
  s_mov_b32 s23, 0x20000
  s_mov_b32 s24, s10
  s_and_b32 s25, s11, 0xffff
  s_mov_b32 s26, 32768
  s_mov_b32 s27, 0x20000
  s_mov_b32 s28, s12
  s_and_b32 s29, s13, 0xffff
  s_mov_b32 s30, 67108864
  s_mov_b32 s31, 0x20000
  s_barrier
  v_lshlrev_b32 v5, 2, v2
  v_xor_b32 v5, v5, v3
  v_lshlrev_b32 v5, 4, v5
  v_lshl_add_u32 v5, v2, 8, v5
  s_lshl_b32 s36, s33, 13
  s_mov_b32 m0, s36
  s_add_u32 s37, s36, 4096
  buffer_load_dwordx4 v5, s[20:23], s36 offen offset:0 lds
  buffer_load_dwordx4 v5, s[20:23], s36 offen offset:1024 lds
  buffer_load_dwordx4 v5, s[20:23], s36 offen offset:2048 lds
  buffer_load_dwordx4 v5, s[20:23], s36 offen offset:3072 lds
  s_mov_b32 m0, s37
  s_nop 0
  buffer_load_dwordx4 v5, s[20:23], s37 offen offset:0 lds
  buffer_load_dwordx4 v5, s[20:23], s37 offen offset:1024 lds
  buffer_load_dwordx4 v5, s[20:23], s37 offen offset:2048 lds
  buffer_load_dwordx4 v5, s[20:23], s37 offen offset:3072 lds
  s_lshl_b32 s38, s33, 2
  v_xor_b32 v6, v3, v2
  v_xor_b32 v6, s38, v6
  v_lshlrev_b32 v6, 4, v6
  v_lshl_add_u32 v6, v2, 8, v6
  s_lshl_b32 s38, s33, 11
  s_add_u32 s39, s38, 0
  s_add_u32 s40, s39, 32768
  s_mov_b32 m0, s40
  s_nop 0
  buffer_load_dwordx4 v6, s[24:27], s39 offen lds
  buffer_load_dwordx4 v6, s[24:27], s39 offen offset:1024 lds
  s_add_u32 s39, s38, 8192
  s_add_u32 s40, s39, 32768
  s_mov_b32 m0, s40
  s_nop 0
  buffer_load_dwordx4 v6, s[24:27], s39 offen lds
  buffer_load_dwordx4 v6, s[24:27], s39 offen offset:1024 lds
  s_add_u32 s39, s38, 16384
  s_add_u32 s40, s39, 32768
  s_mov_b32 m0, s40
  s_nop 0
  buffer_load_dwordx4 v6, s[24:27], s39 offen lds
  buffer_load_dwordx4 v6, s[24:27], s39 offen offset:1024 lds
  s_add_u32 s39, s38, 24576
  s_add_u32 s40, s39, 32768
  s_mov_b32 m0, s40
  s_nop 0
  buffer_load_dwordx4 v6, s[24:27], s39 offen lds
  buffer_load_dwordx4 v6, s[24:27], s39 offen offset:1024 lds
  v_bfe_u32 v232, v1, 2, 2
  v_and_b32 v233, 3, v1
  v_lshl_add_u32 v234, v2, 3, v232
  v_lshlrev_b32 v234, 8, v234
  v_lshl_add_u32 v234, v233, 4, v234
  v_lshl_add_u32 v240, v232, 6, v234
  v_xor_b32 v241, 64, v240
  v_xor_b32 v242, 128, v240
  v_xor_b32 v243, 192, v240
  v_lshrrev_b32 v244, 2, v3
  v_lshlrev_b32 v244, 3, v244
  v_and_b32 v232, 3, v3
  v_add_u32 v244, v244, v232
  v_lshlrev_b32 v244, 8, v244
  v_xor_b32 v232, v2, v3
  v_lshl_add_u32 v244, v232, 4, v244
  v_add_u32 v244, 32768, v244
  v_xor_b32 v245, 64, v244
  v_xor_b32 v246, 128, v244
  v_xor_b32 v247, 192, v244
  v_cmp_eq_u32 s[42:43], 3, v2
  v_lshlrev_b32 v5, 4, v1
  v_lshlrev_b32 v6, 2, v3
  s_add_u32 s45, s35, 8388608
  s_add_u32 s46, s35, 4194304
  s_lshl_b32 s47, s34, 6
  s_add_u32 s47, s47, 60817408
  s_cmp_eq_u32 s34, 781
  s_cselect_b32 s48, 0, 4
  v_cmp_lt_u32 s[50:51], s48, v2
  s_mov_b32 s41, 0xffff0000
  s_waitcnt vmcnt(16)
  v_lshlrev_b32 v24, 16, v8
  v_and_b32 v25, s41, v8
  v_lshlrev_b32 v26, 16, v9
  v_and_b32 v27, s41, v9
  v_lshlrev_b32 v28, 16, v10
  v_and_b32 v29, s41, v10
  v_lshlrev_b32 v30, 16, v11
  v_and_b32 v31, s41, v11
  v_lshlrev_b32 v32, 16, v12
  v_and_b32 v33, s41, v12
  v_lshlrev_b32 v34, 16, v13
  v_and_b32 v35, s41, v13
  v_lshlrev_b32 v36, 16, v14
  v_and_b32 v37, s41, v14
  v_lshlrev_b32 v38, 16, v15
  v_and_b32 v39, s41, v15
  v_lshlrev_b32 v40, 16, v16
  v_and_b32 v41, s41, v16
  v_lshlrev_b32 v42, 16, v17
  v_and_b32 v43, s41, v17
  v_lshlrev_b32 v44, 16, v18
  v_and_b32 v45, s41, v18
  v_lshlrev_b32 v46, 16, v19
  v_and_b32 v47, s41, v19
  v_lshlrev_b32 v48, 16, v20
  v_and_b32 v49, s41, v20
  v_lshlrev_b32 v50, 16, v21
  v_and_b32 v51, s41, v21
  v_lshlrev_b32 v52, 16, v22
  v_and_b32 v53, s41, v22
  v_lshlrev_b32 v54, 16, v23
  v_and_b32 v55, s41, v23
  v_pk_add_f32 v[232:233], v[24:25], v[32:33]
  v_pk_add_f32 v[234:235], v[26:27], v[34:35]
  v_pk_add_f32 v[236:237], v[28:29], v[36:37]
  v_pk_add_f32 v[238:239], v[30:31], v[38:39]
  v_pk_add_f32 v[232:233], v[232:233], v[40:41]
  v_pk_add_f32 v[234:235], v[234:235], v[42:43]
  v_pk_add_f32 v[236:237], v[236:237], v[44:45]
  v_pk_add_f32 v[238:239], v[238:239], v[46:47]
  v_pk_add_f32 v[232:233], v[232:233], v[48:49]
  v_pk_add_f32 v[234:235], v[234:235], v[50:51]
  v_pk_add_f32 v[236:237], v[236:237], v[52:53]
  v_pk_add_f32 v[238:239], v[238:239], v[54:55]
  v_pk_add_f32 v[232:233], v[232:233], v[234:235]
  v_pk_add_f32 v[236:237], v[236:237], v[238:239]
  v_pk_add_f32 v[232:233], v[232:233], v[236:237]
  v_add_f32 v232, v232, v233
  v_mov_b32 v233, v232
  s_nop 1
  v_permlane16_swap_b32 v232, v233
  v_add_f32 v232, v232, v233
  v_mov_b32 v233, v232
  s_nop 1
  v_permlane32_swap_b32 v232, v233
  v_add_f32 v232, v232, v233
  v_mul_f32 v232, 0x3c000000, v232
  v_pk_add_f32 v[24:25], v[24:25], v[232:233] op_sel_hi:[1,0] neg_lo:[0,1] neg_hi:[0,1]
  v_pk_add_f32 v[26:27], v[26:27], v[232:233] op_sel_hi:[1,0] neg_lo:[0,1] neg_hi:[0,1]
  v_pk_add_f32 v[28:29], v[28:29], v[232:233] op_sel_hi:[1,0] neg_lo:[0,1] neg_hi:[0,1]
  v_pk_add_f32 v[30:31], v[30:31], v[232:233] op_sel_hi:[1,0] neg_lo:[0,1] neg_hi:[0,1]
  v_pk_add_f32 v[32:33], v[32:33], v[232:233] op_sel_hi:[1,0] neg_lo:[0,1] neg_hi:[0,1]
  v_pk_add_f32 v[34:35], v[34:35], v[232:233] op_sel_hi:[1,0] neg_lo:[0,1] neg_hi:[0,1]
  v_pk_add_f32 v[36:37], v[36:37], v[232:233] op_sel_hi:[1,0] neg_lo:[0,1] neg_hi:[0,1]
  v_pk_add_f32 v[38:39], v[38:39], v[232:233] op_sel_hi:[1,0] neg_lo:[0,1] neg_hi:[0,1]
  v_pk_add_f32 v[40:41], v[40:41], v[232:233] op_sel_hi:[1,0] neg_lo:[0,1] neg_hi:[0,1]
  v_pk_add_f32 v[42:43], v[42:43], v[232:233] op_sel_hi:[1,0] neg_lo:[0,1] neg_hi:[0,1]
  v_pk_add_f32 v[44:45], v[44:45], v[232:233] op_sel_hi:[1,0] neg_lo:[0,1] neg_hi:[0,1]
  v_pk_add_f32 v[46:47], v[46:47], v[232:233] op_sel_hi:[1,0] neg_lo:[0,1] neg_hi:[0,1]
  v_pk_add_f32 v[48:49], v[48:49], v[232:233] op_sel_hi:[1,0] neg_lo:[0,1] neg_hi:[0,1]
  v_pk_add_f32 v[50:51], v[50:51], v[232:233] op_sel_hi:[1,0] neg_lo:[0,1] neg_hi:[0,1]
  v_pk_add_f32 v[52:53], v[52:53], v[232:233] op_sel_hi:[1,0] neg_lo:[0,1] neg_hi:[0,1]
  v_pk_add_f32 v[54:55], v[54:55], v[232:233] op_sel_hi:[1,0] neg_lo:[0,1] neg_hi:[0,1]
  s_waitcnt vmcnt(8)
  s_barrier
  v_pk_mul_f32 v[232:233], v[24:25], v[24:25]
  ds_read_b64_tr_b16 v[120:121], v240 offset:0
  v_pk_mul_f32 v[234:235], v[26:27], v[26:27]
  ds_read_b64_tr_b16 v[122:123], v240 offset:1024
  v_pk_mul_f32 v[236:237], v[28:29], v[28:29]
  ds_read_b64_tr_b16 v[124:125], v240 offset:8192
  v_pk_mul_f32 v[238:239], v[30:31], v[30:31]
  ds_read_b64_tr_b16 v[126:127], v240 offset:9216
  v_pk_fma_f32 v[232:233], v[32:33], v[32:33], v[232:233]
  ds_read_b64_tr_b16 v[128:129], v240 offset:16384
  v_pk_fma_f32 v[234:235], v[34:35], v[34:35], v[234:235]
  ds_read_b64_tr_b16 v[130:131], v240 offset:17408
  v_pk_fma_f32 v[236:237], v[36:37], v[36:37], v[236:237]
  ds_read_b64_tr_b16 v[132:133], v240 offset:24576
  v_pk_fma_f32 v[238:239], v[38:39], v[38:39], v[238:239]
  ds_read_b64_tr_b16 v[134:135], v240 offset:25600
  v_pk_fma_f32 v[232:233], v[40:41], v[40:41], v[232:233]
  ds_read_b64_tr_b16 v[136:137], v240 offset:8
  v_pk_fma_f32 v[234:235], v[42:43], v[42:43], v[234:235]
  ds_read_b64_tr_b16 v[138:139], v240 offset:1032
  v_pk_fma_f32 v[236:237], v[44:45], v[44:45], v[236:237]
  ds_read_b64_tr_b16 v[140:141], v240 offset:8200
  v_pk_fma_f32 v[238:239], v[46:47], v[46:47], v[238:239]
  ds_read_b64_tr_b16 v[142:143], v240 offset:9224
  v_pk_fma_f32 v[232:233], v[48:49], v[48:49], v[232:233]
  ds_read_b64_tr_b16 v[144:145], v240 offset:16392
  v_pk_fma_f32 v[234:235], v[50:51], v[50:51], v[234:235]
  ds_read_b64_tr_b16 v[146:147], v240 offset:17416
  v_pk_fma_f32 v[236:237], v[52:53], v[52:53], v[236:237]
  ds_read_b64_tr_b16 v[148:149], v240 offset:24584
  v_pk_fma_f32 v[238:239], v[54:55], v[54:55], v[238:239]
  ds_read_b64_tr_b16 v[150:151], v240 offset:25608
  v_pk_add_f32 v[232:233], v[232:233], v[234:235]
  ds_read_b64_tr_b16 v[152:153], v241 offset:0
  v_pk_add_f32 v[236:237], v[236:237], v[238:239]
  ds_read_b64_tr_b16 v[154:155], v241 offset:1024
  v_pk_add_f32 v[232:233], v[232:233], v[236:237]
  ds_read_b64_tr_b16 v[156:157], v241 offset:8192
  v_add_f32 v232, v232, v233
  ds_read_b64_tr_b16 v[158:159], v241 offset:9216
  v_mov_b32 v233, v232
  ds_read_b64_tr_b16 v[160:161], v241 offset:16384
  s_nop 0
  v_permlane16_swap_b32 v232, v233
  ds_read_b64_tr_b16 v[162:163], v241 offset:17408
  v_add_f32 v232, v232, v233
  ds_read_b64_tr_b16 v[164:165], v241 offset:24576
  v_mov_b32 v233, v232
  ds_read_b64_tr_b16 v[166:167], v241 offset:25600
  s_nop 0
  v_permlane32_swap_b32 v232, v233
  ds_read_b64_tr_b16 v[168:169], v241 offset:8
  v_add_f32 v232, v232, v233
  ds_read_b64_tr_b16 v[170:171], v241 offset:1032
  v_mov_b32 v235, v55
  ds_read_b64_tr_b16 v[172:173], v241 offset:8200
  v_mov_b32 v234, v55
  ds_read_b64_tr_b16 v[174:175], v241 offset:9224
  s_nop 0
  v_permlane32_swap_b32 v235, v234
  ds_read_b64_tr_b16 v[176:177], v241 offset:16392
  v_mov_b32 v235, v234
  ds_read_b64_tr_b16 v[178:179], v241 offset:17416
  s_nop 0
  v_permlane16_swap_b32 v235, v234
  ds_read_b64_tr_b16 v[180:181], v241 offset:24584
  v_mul_f32 v232, 0x3c000000, v232
  ds_read_b64_tr_b16 v[182:183], v241 offset:25608
  v_cvt_pk_bf16_f32 v233, v232, v232
  ds_read_b64_tr_b16 v[184:185], v242 offset:0
  v_lshlrev_b32 v232, 16, v233
  ds_read_b64_tr_b16 v[186:187], v242 offset:1024
  v_add_f32 v232, 0x3727c5ac, v232
  ds_read_b64_tr_b16 v[188:189], v242 offset:8192
  v_cvt_pk_bf16_f32 v233, v232, v232
  ds_read_b64_tr_b16 v[190:191], v242 offset:9216
  v_lshlrev_b32 v232, 16, v233
  ds_read_b64_tr_b16 v[192:193], v242 offset:16384
  v_sqrt_f32 v232, v232
  ds_read_b64_tr_b16 v[194:195], v242 offset:17408
  v_cvt_pk_bf16_f32 v233, v232, v232
  ds_read_b64_tr_b16 v[196:197], v242 offset:24576
  v_lshlrev_b32 v232, 16, v233
  ds_read_b64_tr_b16 v[198:199], v242 offset:25600
  v_rcp_f32 v232, v232
  ds_read_b64_tr_b16 v[200:201], v242 offset:8
  v_mul_f32 v234, 0x3dc69217, v234
  ds_read_b64_tr_b16 v[202:203], v242 offset:1032
  v_mul_f32 v234, v234, v232
  ds_read_b64_tr_b16 v[204:205], v242 offset:8200
  v_pk_mul_f32 v[248:249], v[24:25], v[232:233] op_sel_hi:[1,0]
  ds_read_b64_tr_b16 v[206:207], v242 offset:9224
  v_cvt_pk_bf16_f32 v56, v248, v249
  ds_read_b64_tr_b16 v[208:209], v242 offset:16392
  v_pk_mul_f32 v[250:251], v[26:27], v[232:233] op_sel_hi:[1,0]
  ds_read_b64_tr_b16 v[210:211], v242 offset:17416
  v_cvt_pk_bf16_f32 v57, v250, v251
  ds_read_b64_tr_b16 v[212:213], v242 offset:24584
  v_pk_mul_f32 v[252:253], v[28:29], v[232:233] op_sel_hi:[1,0]
  ds_read_b64_tr_b16 v[214:215], v242 offset:25608
  v_cvt_pk_bf16_f32 v58, v252, v253
  ds_read_b64_tr_b16 v[216:217], v243 offset:0
  v_pk_mul_f32 v[254:255], v[30:31], v[232:233] op_sel_hi:[1,0]
  ds_read_b64_tr_b16 v[218:219], v243 offset:1024
  v_cvt_pk_bf16_f32 v59, v254, v255
  ds_read_b64_tr_b16 v[220:221], v243 offset:8192
  v_pk_mul_f32 v[248:249], v[32:33], v[232:233] op_sel_hi:[1,0]
  ds_read_b64_tr_b16 v[222:223], v243 offset:9216
  v_cvt_pk_bf16_f32 v60, v248, v249
  ds_read_b64_tr_b16 v[224:225], v243 offset:16384
  v_pk_mul_f32 v[250:251], v[34:35], v[232:233] op_sel_hi:[1,0]
  ds_read_b64_tr_b16 v[226:227], v243 offset:17408
  v_cvt_pk_bf16_f32 v61, v250, v251
  ds_read_b64_tr_b16 v[228:229], v243 offset:24576
  v_pk_mul_f32 v[252:253], v[36:37], v[232:233] op_sel_hi:[1,0]
  ds_read_b64_tr_b16 v[230:231], v243 offset:25600
  v_cvt_pk_bf16_f32 v62, v252, v253
  v_pk_mul_f32 v[254:255], v[38:39], v[232:233] op_sel_hi:[1,0]
  v_cvt_pk_bf16_f32 v63, v254, v255
  v_pk_mul_f32 v[248:249], v[40:41], v[232:233] op_sel_hi:[1,0]
  v_cvt_pk_bf16_f32 v64, v248, v249
  v_pk_mul_f32 v[250:251], v[42:43], v[232:233] op_sel_hi:[1,0]
  v_cvt_pk_bf16_f32 v65, v250, v251
  v_pk_mul_f32 v[252:253], v[44:45], v[232:233] op_sel_hi:[1,0]
  v_cvt_pk_bf16_f32 v66, v252, v253
  v_pk_mul_f32 v[254:255], v[46:47], v[232:233] op_sel_hi:[1,0]
  v_cvt_pk_bf16_f32 v67, v254, v255
  v_pk_mul_f32 v[248:249], v[48:49], v[232:233] op_sel_hi:[1,0]
  v_cvt_pk_bf16_f32 v68, v248, v249
  v_pk_mul_f32 v[250:251], v[50:51], v[232:233] op_sel_hi:[1,0]
  v_cvt_pk_bf16_f32 v69, v250, v251
  v_pk_mul_f32 v[252:253], v[52:53], v[232:233] op_sel_hi:[1,0]
  v_cvt_pk_bf16_f32 v70, v252, v253
  v_pk_mul_f32 v[254:255], v[54:55], v[232:233] op_sel_hi:[1,0]
  v_cvt_pk_bf16_f32 v71, v254, v255
  s_waitcnt lgkmcnt(15)
  v_mfma_f32_16x16x32_bf16 v[88:91], v[120:123], v[56:59], 0
  v_mfma_f32_16x16x32_bf16 v[88:91], v[124:127], v[60:63], v[88:91]
  v_mfma_f32_16x16x32_bf16 v[88:91], v[128:131], v[64:67], v[88:91]
  v_mfma_f32_16x16x32_bf16 v[88:91], v[132:135], v[68:71], v[88:91]
  s_waitcnt vmcnt(0)
  s_barrier
  v_mfma_f32_16x16x32_bf16 v[92:95], v[136:139], v[56:59], 0
  ds_read_b64_tr_b16 v[120:121], v243 offset:8
  ds_read_b64_tr_b16 v[122:123], v243 offset:1032
  v_mfma_f32_16x16x32_bf16 v[92:95], v[140:143], v[60:63], v[92:95]
  ds_read_b64_tr_b16 v[124:125], v243 offset:8200
  ds_read_b64_tr_b16 v[126:127], v243 offset:9224
  v_mfma_f32_16x16x32_bf16 v[92:95], v[144:147], v[64:67], v[92:95]
  ds_read_b64_tr_b16 v[128:129], v243 offset:16392
  ds_read_b64_tr_b16 v[130:131], v243 offset:17416
  v_mfma_f32_16x16x32_bf16 v[92:95], v[148:151], v[68:71], v[92:95]
  ds_read_b64_tr_b16 v[132:133], v243 offset:24584
  ds_read_b64_tr_b16 v[134:135], v243 offset:25608
  v_mfma_f32_16x16x32_bf16 v[96:99], v[152:155], v[56:59], 0
  ds_read_b128 v[136:139], v244 offset:0
  ds_read_b128 v[140:143], v245 offset:0
  v_mfma_f32_16x16x32_bf16 v[96:99], v[156:159], v[60:63], v[96:99]
  ds_read_b128 v[144:147], v246 offset:0
  ds_read_b128 v[148:151], v247 offset:0
  v_mfma_f32_16x16x32_bf16 v[96:99], v[160:163], v[64:67], v[96:99]
  v_pk_fma_f32 v[248:249], v[24:25], v[232:233], v[234:235] op_sel_hi:[1,0,0]
  v_cvt_pk_bf16_f32 v72, v248, v249
  v_mfma_f32_16x16x32_bf16 v[96:99], v[164:167], v[68:71], v[96:99]
  v_pk_fma_f32 v[250:251], v[26:27], v[232:233], v[234:235] op_sel_hi:[1,0,0]
  v_cvt_pk_bf16_f32 v73, v250, v251
  v_mfma_f32_16x16x32_bf16 v[100:103], v[168:171], v[56:59], 0
  v_cvt_pk_bf16_f32 v8, v88, v89
  v_cvt_pk_bf16_f32 v9, v90, v91
  v_mfma_f32_16x16x32_bf16 v[100:103], v[172:175], v[60:63], v[100:103]
  ds_read_b128 v[152:155], v244 offset:1024
  ds_read_b128 v[156:159], v245 offset:1024
  v_mfma_f32_16x16x32_bf16 v[100:103], v[176:179], v[64:67], v[100:103]
  ds_read_b128 v[160:163], v246 offset:1024
  ds_read_b128 v[164:167], v247 offset:1024
  v_mfma_f32_16x16x32_bf16 v[100:103], v[180:183], v[68:71], v[100:103]
  v_pk_fma_f32 v[252:253], v[28:29], v[232:233], v[234:235] op_sel_hi:[1,0,0]
  v_cvt_pk_bf16_f32 v74, v252, v253
  v_mfma_f32_16x16x32_bf16 v[104:107], v[184:187], v[56:59], 0
  v_cvt_pk_bf16_f32 v10, v92, v93
  v_cvt_pk_bf16_f32 v11, v94, v95
  v_mfma_f32_16x16x32_bf16 v[104:107], v[188:191], v[60:63], v[104:107]
  ds_read_b128 v[168:171], v244 offset:8192
  ds_read_b128 v[172:175], v245 offset:8192
  v_mfma_f32_16x16x32_bf16 v[104:107], v[192:195], v[64:67], v[104:107]
  ds_read_b128 v[176:179], v246 offset:8192
  ds_read_b128 v[180:183], v247 offset:8192
  v_mfma_f32_16x16x32_bf16 v[104:107], v[196:199], v[68:71], v[104:107]
  v_pk_fma_f32 v[254:255], v[30:31], v[232:233], v[234:235] op_sel_hi:[1,0,0]
  v_cvt_pk_bf16_f32 v75, v254, v255
  s_waitcnt lgkmcnt(15)
  v_mfma_f32_16x16x32_bf16 v[108:111], v[200:203], v[56:59], 0
  v_cvt_pk_bf16_f32 v12, v96, v97
  v_cvt_pk_bf16_f32 v13, v98, v99
  v_mfma_f32_16x16x32_bf16 v[108:111], v[204:207], v[60:63], v[108:111]
  ds_read_b128 v[184:187], v244 offset:9216
  ds_read_b128 v[188:191], v245 offset:9216
  v_mfma_f32_16x16x32_bf16 v[108:111], v[208:211], v[64:67], v[108:111]
  ds_read_b128 v[192:195], v246 offset:9216
  ds_read_b128 v[196:199], v247 offset:9216
  v_mfma_f32_16x16x32_bf16 v[108:111], v[212:215], v[68:71], v[108:111]
  buffer_store_dwordx4 v[72:75], v4, s[28:31], s45 offen offset:0 sc1
  v_pk_fma_f32 v[248:249], v[32:33], v[232:233], v[234:235] op_sel_hi:[1,0,0]
  v_mfma_f32_16x16x32_bf16 v[112:115], v[216:219], v[56:59], 0
  v_cvt_pk_bf16_f32 v14, v100, v101
  v_cvt_pk_bf16_f32 v15, v102, v103
  v_mfma_f32_16x16x32_bf16 v[112:115], v[220:223], v[60:63], v[112:115]
  ds_read_b128 v[200:203], v244 offset:16384
  ds_read_b128 v[204:207], v245 offset:16384
  v_mfma_f32_16x16x32_bf16 v[112:115], v[224:227], v[64:67], v[112:115]
  ds_read_b128 v[208:211], v246 offset:16384
  ds_read_b128 v[212:215], v247 offset:16384
  v_mfma_f32_16x16x32_bf16 v[112:115], v[228:231], v[68:71], v[112:115]
  v_cvt_pk_bf16_f32 v76, v248, v249
  v_pk_fma_f32 v[250:251], v[34:35], v[232:233], v[234:235] op_sel_hi:[1,0,0]
  v_mfma_f32_16x16x32_bf16 v[116:119], v[120:123], v[56:59], 0
  v_cvt_pk_bf16_f32 v16, v104, v105
  v_cvt_pk_bf16_f32 v17, v106, v107
  v_mfma_f32_16x16x32_bf16 v[116:119], v[124:127], v[60:63], v[116:119]
  ds_read_b128 v[216:219], v244 offset:17408
  ds_read_b128 v[220:223], v245 offset:17408
  s_waitcnt lgkmcnt(15)
  v_mfma_f32_16x16x32_bf16 v[116:119], v[128:131], v[64:67], v[116:119]
  ds_read_b128 v[224:227], v246 offset:17408
  ds_read_b128 v[228:231], v247 offset:17408
  v_mfma_f32_16x16x32_bf16 v[116:119], v[132:135], v[68:71], v[116:119]
  v_cvt_pk_bf16_f32 v77, v250, v251
  v_pk_fma_f32 v[252:253], v[36:37], v[232:233], v[234:235] op_sel_hi:[1,0,0]
  v_cvt_pk_bf16_f32 v18, v108, v109
  v_cvt_pk_bf16_f32 v19, v110, v111
  ds_read_b128 v[120:123], v244 offset:24576
  ds_read_b128 v[124:127], v245 offset:24576
  ds_read_b128 v[128:131], v246 offset:24576
  ds_read_b128 v[132:135], v247 offset:24576
  v_cvt_pk_bf16_f32 v78, v252, v253
  v_pk_fma_f32 v[254:255], v[38:39], v[232:233], v[234:235] op_sel_hi:[1,0,0]
  v_cvt_pk_bf16_f32 v79, v254, v255
  buffer_store_dwordx4 v[76:79], v4, s[28:31], s45 offen offset:64 sc1
  v_pk_fma_f32 v[248:249], v[40:41], v[232:233], v[234:235] op_sel_hi:[1,0,0]
  v_cvt_pk_bf16_f32 v80, v248, v249
  v_pk_fma_f32 v[250:251], v[42:43], v[232:233], v[234:235] op_sel_hi:[1,0,0]
  v_cvt_pk_bf16_f32 v81, v250, v251
  v_pk_fma_f32 v[252:253], v[44:45], v[232:233], v[234:235] op_sel_hi:[1,0,0]
  v_cvt_pk_bf16_f32 v82, v252, v253
  v_pk_fma_f32 v[254:255], v[46:47], v[232:233], v[234:235] op_sel_hi:[1,0,0]
  v_cvt_pk_bf16_f32 v83, v254, v255
  buffer_store_dwordx4 v[80:83], v4, s[28:31], s45 offen offset:128 sc1
  v_pk_fma_f32 v[248:249], v[48:49], v[232:233], v[234:235] op_sel_hi:[1,0,0]
  v_cvt_pk_bf16_f32 v84, v248, v249
  v_pk_fma_f32 v[250:251], v[50:51], v[232:233], v[234:235] op_sel_hi:[1,0,0]
  v_cvt_pk_bf16_f32 v85, v250, v251
  v_pk_fma_f32 v[252:253], v[52:53], v[232:233], v[234:235] op_sel_hi:[1,0,0]
  v_cvt_pk_bf16_f32 v86, v252, v253
  v_pk_fma_f32 v[254:255], v[54:55], v[232:233], v[234:235] op_sel_hi:[1,0,0]
  v_cndmask_b32 v255, v255, 1.0, s[42:43]
  v_cvt_pk_bf16_f32 v87, v254, v255
  buffer_store_dwordx4 v[84:87], v4, s[28:31], s45 offen offset:192 sc1
  v_cvt_pk_bf16_f32 v20, v112, v113
  v_cvt_pk_bf16_f32 v21, v114, v115
  v_cvt_pk_bf16_f32 v22, v116, v117
  v_cvt_pk_bf16_f32 v23, v118, v119
  v_mfma_f32_16x16x32_bf16 v[24:27], v[136:139], v[8:11], 0
  v_mfma_f32_16x16x32_bf16 v[24:27], v[140:143], v[12:15], v[24:27]
  v_mfma_f32_16x16x32_bf16 v[24:27], v[144:147], v[16:19], v[24:27]
  v_mfma_f32_16x16x32_bf16 v[24:27], v[148:151], v[20:23], v[24:27]
  v_mfma_f32_16x16x32_bf16 v[28:31], v[152:155], v[8:11], 0
  ds_read_b128 v[136:139], v244 offset:25600
  ds_read_b128 v[140:143], v245 offset:25600
  v_mfma_f32_16x16x32_bf16 v[28:31], v[156:159], v[12:15], v[28:31]
  ds_read_b128 v[144:147], v246 offset:25600
  ds_read_b128 v[148:151], v247 offset:25600
  v_mfma_f32_16x16x32_bf16 v[28:31], v[160:163], v[16:19], v[28:31]
  s_waitcnt lgkmcnt(15)
  v_mfma_f32_16x16x32_bf16 v[28:31], v[164:167], v[20:23], v[28:31]
  v_mfma_f32_16x16x32_bf16 v[32:35], v[168:171], v[8:11], 0
  v_mfma_f32_16x16x32_bf16 v[32:35], v[172:175], v[12:15], v[32:35]
  v_mfma_f32_16x16x32_bf16 v[32:35], v[176:179], v[16:19], v[32:35]
  v_mfma_f32_16x16x32_bf16 v[32:35], v[180:183], v[20:23], v[32:35]
  v_mfma_f32_16x16x32_bf16 v[36:39], v[184:187], v[8:11], 0
  v_mfma_f32_16x16x32_bf16 v[36:39], v[188:191], v[12:15], v[36:39]
  v_mfma_f32_16x16x32_bf16 v[36:39], v[192:195], v[16:19], v[36:39]
  v_mfma_f32_16x16x32_bf16 v[36:39], v[196:199], v[20:23], v[36:39]
  v_mfma_f32_16x16x32_bf16 v[40:43], v[200:203], v[8:11], 0
  v_pk_add_f32 v[232:233], v[24:25], v[28:29]
  v_pk_add_f32 v[234:235], v[26:27], v[30:31]
  s_waitcnt lgkmcnt(14)
  v_mfma_f32_16x16x32_bf16 v[40:43], v[204:207], v[12:15], v[40:43]
  s_waitcnt lgkmcnt(13)
  v_mfma_f32_16x16x32_bf16 v[40:43], v[208:211], v[16:19], v[40:43]
  s_waitcnt lgkmcnt(12)
  v_mfma_f32_16x16x32_bf16 v[40:43], v[212:215], v[20:23], v[40:43]
  s_waitcnt lgkmcnt(11)
  v_mfma_f32_16x16x32_bf16 v[44:47], v[216:219], v[8:11], 0
  v_pk_add_f32 v[232:233], v[232:233], v[32:33]
  v_pk_add_f32 v[234:235], v[234:235], v[34:35]
  s_waitcnt lgkmcnt(10)
  v_mfma_f32_16x16x32_bf16 v[44:47], v[220:223], v[12:15], v[44:47]
  s_waitcnt lgkmcnt(9)
  v_mfma_f32_16x16x32_bf16 v[44:47], v[224:227], v[16:19], v[44:47]
  s_waitcnt lgkmcnt(8)
  v_mfma_f32_16x16x32_bf16 v[44:47], v[228:231], v[20:23], v[44:47]
  s_waitcnt lgkmcnt(7)
  v_mfma_f32_16x16x32_bf16 v[48:51], v[120:123], v[8:11], 0
  v_pk_add_f32 v[232:233], v[232:233], v[36:37]
  v_pk_add_f32 v[234:235], v[234:235], v[38:39]
  s_waitcnt lgkmcnt(6)
  v_mfma_f32_16x16x32_bf16 v[48:51], v[124:127], v[12:15], v[48:51]
  s_waitcnt lgkmcnt(5)
  v_mfma_f32_16x16x32_bf16 v[48:51], v[128:131], v[16:19], v[48:51]
  s_waitcnt lgkmcnt(4)
  v_mfma_f32_16x16x32_bf16 v[48:51], v[132:135], v[20:23], v[48:51]
  s_waitcnt lgkmcnt(3)
  v_mfma_f32_16x16x32_bf16 v[52:55], v[136:139], v[8:11], 0
  v_pk_add_f32 v[232:233], v[232:233], v[40:41]
  v_pk_add_f32 v[234:235], v[234:235], v[42:43]
  s_waitcnt lgkmcnt(2)
  v_mfma_f32_16x16x32_bf16 v[52:55], v[140:143], v[12:15], v[52:55]
  s_waitcnt lgkmcnt(1)
  v_mfma_f32_16x16x32_bf16 v[52:55], v[144:147], v[16:19], v[52:55]
  s_waitcnt lgkmcnt(0)
  v_mfma_f32_16x16x32_bf16 v[52:55], v[148:151], v[20:23], v[52:55]
  v_pk_add_f32 v[232:233], v[232:233], v[44:45]
  v_pk_add_f32 v[234:235], v[234:235], v[46:47]
  v_pk_add_f32 v[232:233], v[232:233], v[48:49]
  v_pk_add_f32 v[234:235], v[234:235], v[50:51]
  s_nop 3
  v_pk_add_f32 v[232:233], v[232:233], v[52:53]
  v_pk_add_f32 v[234:235], v[234:235], v[54:55]
  v_pk_add_f32 v[232:233], v[232:233], v[234:235]
  v_add_f32 v232, v232, v233
  v_mul_f32 v234, 0x3c4a91dd, v55
  v_mul_f32 v232, 0xba8f3d0c, v232
  v_cndmask_b32 v234, 0, v234, s[42:43]
  v_add_f32 v232, v232, v234
  v_mov_b32 v234, 0x3e0293ee
  v_mov_b32 v233, v232
  s_nop 1
  v_permlane16_swap_b32 v232, v233
  v_add_f32 v232, v232, v233
  v_mov_b32 v233, v232
  s_nop 1
  v_permlane32_swap_b32 v232, v233
  v_add_f32 v232, v232, v233
  v_pk_fma_f32 v[24:25], v[24:25], v[234:235], v[232:233] op_sel_hi:[1,0,0]
  v_cvt_pk_bf16_f32 v8, v24, v25
  v_pk_fma_f32 v[26:27], v[26:27], v[234:235], v[232:233] op_sel_hi:[1,0,0]
  v_cvt_pk_bf16_f32 v9, v26, v27
  v_pk_fma_f32 v[28:29], v[28:29], v[234:235], v[232:233] op_sel_hi:[1,0,0]
  v_cvt_pk_bf16_f32 v10, v28, v29
  v_pk_fma_f32 v[30:31], v[30:31], v[234:235], v[232:233] op_sel_hi:[1,0,0]
  v_cvt_pk_bf16_f32 v11, v30, v31
  buffer_store_dwordx4 v[8:11], v5, s[28:31], s46 offen offset:0 sc1
  s_nop 0
  v_mfma_f32_16x16x32_bf16 v[248:251], v[72:75], v[8:11], 0
  v_pk_fma_f32 v[32:33], v[32:33], v[234:235], v[232:233] op_sel_hi:[1,0,0]
  v_cvt_pk_bf16_f32 v12, v32, v33
  v_pk_fma_f32 v[34:35], v[34:35], v[234:235], v[232:233] op_sel_hi:[1,0,0]
  v_cvt_pk_bf16_f32 v13, v34, v35
  v_pk_fma_f32 v[36:37], v[36:37], v[234:235], v[232:233] op_sel_hi:[1,0,0]
  v_cvt_pk_bf16_f32 v14, v36, v37
  v_pk_fma_f32 v[38:39], v[38:39], v[234:235], v[232:233] op_sel_hi:[1,0,0]
  v_cvt_pk_bf16_f32 v15, v38, v39
  buffer_store_dwordx4 v[12:15], v5, s[28:31], s46 offen offset:1024 sc1
  s_nop 0
  v_mfma_f32_16x16x32_bf16 v[248:251], v[76:79], v[12:15], v[248:251]
  v_pk_fma_f32 v[40:41], v[40:41], v[234:235], v[232:233] op_sel_hi:[1,0,0]
  v_cvt_pk_bf16_f32 v16, v40, v41
  v_pk_fma_f32 v[42:43], v[42:43], v[234:235], v[232:233] op_sel_hi:[1,0,0]
  v_cvt_pk_bf16_f32 v17, v42, v43
  v_pk_fma_f32 v[44:45], v[44:45], v[234:235], v[232:233] op_sel_hi:[1,0,0]
  v_cvt_pk_bf16_f32 v18, v44, v45
  v_pk_fma_f32 v[46:47], v[46:47], v[234:235], v[232:233] op_sel_hi:[1,0,0]
  v_cvt_pk_bf16_f32 v19, v46, v47
  buffer_store_dwordx4 v[16:19], v5, s[28:31], s46 offen offset:2048 sc1
  s_nop 0
  v_mfma_f32_16x16x32_bf16 v[248:251], v[80:83], v[16:19], v[248:251]
  v_pk_fma_f32 v[48:49], v[48:49], v[234:235], v[232:233] op_sel_hi:[1,0,0]
  v_cvt_pk_bf16_f32 v20, v48, v49
  v_pk_fma_f32 v[50:51], v[50:51], v[234:235], v[232:233] op_sel_hi:[1,0,0]
  v_cvt_pk_bf16_f32 v21, v50, v51
  v_pk_fma_f32 v[52:53], v[52:53], v[234:235], v[232:233] op_sel_hi:[1,0,0]
  v_cvt_pk_bf16_f32 v22, v52, v53
  v_pk_fma_f32 v[54:55], v[54:55], v[234:235], v[232:233] op_sel_hi:[1,0,0]
  v_cndmask_b32 v55, v55, 0, s[42:43]
  v_cvt_pk_bf16_f32 v23, v54, v55
  buffer_store_dwordx4 v[20:23], v5, s[28:31], s46 offen offset:3072 sc1
  s_nop 0
  v_mfma_f32_16x16x32_bf16 v[248:251], v[84:87], v[20:23], v[248:251]
  v_mov_b32 v233, 0xff800000
  s_nop 6
  v_max3_f32 v232, v248, v249, v250
  v_max_f32 v232, v232, v251
  v_cndmask_b32 v232, v232, v233, s[50:51]
  v_mov_b32 v233, v232
  s_nop 1
  v_permlane16_swap_b32 v232, v233
  v_max_f32 v232, v232, v233
  v_mov_b32 v233, v232
  s_nop 1
  v_permlane32_swap_b32 v232, v233
  v_max_f32 v232, v232, v233
  v_sub_f32 v232, 0xc2000000, v232
  buffer_store_dword v232, v6, s[28:31], s47 offen sc1
  s_endpgm
.globl gps_attn_kernel
.p2align 8
.type gps_attn_kernel,@function
gps_attn_kernel:
  s_cmp_ge_u32 s2, 249
  s_cbranch_scc1 Lk2_exit
  s_cmp_ge_u32 s2, 245
  s_cbranch_scc1 Lk2_wprep
  s_load_dwordx2 s[12:13], s[0:1], 88
  s_load_dwordx2 s[14:15], s[0:1], 24
  s_load_dwordx2 s[74:75], s[0:1], 0
  s_load_dwordx2 s[76:77], s[0:1], 72
  v_and_b32 v1, 63, v0
  v_lshrrev_b32 v9, 6, v0
Lk2_pfstart:
  v_lshlrev_b32 v4, 4, v1
  v_readfirstlane_b32 s33, v9
  v_and_b32 v3, 15, v1
  v_lshrrev_b32 v2, 4, v1
  v_and_b32 v9, 1, v2
  v_mul_u32_u24 v9, 12, v9
  v_xor_b32 v9, v9, v3
  v_lshlrev_b32 v10, 4, v2
  v_lshl_add_u32 v242, v9, 8, v10
  v_lshlrev_b32 v9, 4, v9
  v_lshl_add_u32 v5, v2, 8, v9
  s_mul_i32 s3, s2, 1639
  s_lshr_b32 s3, s3, 16
  s_mul_i32 s4, s3, 40
  s_sub_u32 s4, s2, s4
  s_lshr_b32 s34, s4, 3
  s_lshl_b32 s5, s34, 2
  s_lshr_b32 s5, 406272, s5
  s_add_u32 s5, s5, s4
  s_and_b32 s5, s5, 7
  s_lshl_b32 s35, s3, 3
  s_add_u32 s35, s35, s5
  s_cmp_ge_u32 s2, 240
  s_cselect_b32 s34, s4, s34
  s_cselect_b32 s35, 48, s35
  s_lshl_b32 s37, s35, 4
  s_lshl_b32 s3, s33, 2
  s_mul_i32 s36, s33, 5
  s_add_u32 s36, s36, s34
  s_cmp_lt_u32 s36, 16
  s_cselect_b32 s4, 0, 0x10000
  s_add_u32 s36, s36, s37
  s_add_u32 s36, s36, s4
  s_add_u32 s37, s37, s3
  s_lshl_b32 s39, s33, 12
  s_add_u32 s39, s39, 8388608
  s_mul_i32 s70, s34, 6
  s_lshl_b32 s38, s37, 12
  s_add_u32 s38, s38, 4194304
  s_mov_b32 s45, 0
  s_min_u32 s47, s36, 1000
  s_lshl_b32 s47, s47, 2
  s_add_u32 s47, s47, 15728640
  v_lshlrev_b32 v11, 13, v1
  s_waitcnt lgkmcnt(0)
  s_mov_b32 s28, s12
  s_and_b32 s29, s13, 0xffff
  s_mov_b32 s30, 67108864
  s_mov_b32 s31, 0x20000
  buffer_load_dwordx2 v[238:239], v11, s[28:31], s47 offen
  s_lshl_b32 s40, s70, 14
  s_add_u32 s40, s40, s39
  s_lshl_b32 s41, s33, 12
  s_mov_b32 m0, s41
  s_nop 0
  buffer_load_dwordx4 v242, s[28:31], s40 offen offset:0 lds
  s_add_u32 m0, m0, 960
  s_nop 0
  buffer_load_dwordx4 v242, s[28:31], s40 offen offset:64 lds
  s_add_u32 m0, m0, 960
  s_nop 0
  buffer_load_dwordx4 v242, s[28:31], s40 offen offset:128 lds
  s_add_u32 m0, m0, 960
  s_nop 0
  buffer_load_dwordx4 v242, s[28:31], s40 offen offset:192 lds
  s_add_u32 s40, s40, 16384
  s_add_u32 s41, s41, 16384
  v_lshlrev_b32 v9, 2, v3
  s_lshl_b32 s46, s37, 6
  s_add_u32 s46, s46, 60817408
  buffer_load_dwordx4 a[0:3], v4, s[28:31], s38 offen offset:0
  buffer_load_dwordx4 a[4:7], v4, s[28:31], s38 offen offset:1024
  buffer_load_dwordx4 a[8:11], v4, s[28:31], s38 offen offset:2048
  buffer_load_dwordx4 a[12:15], v4, s[28:31], s38 offen offset:3072
  s_add_u32 s38, s38, 4096
  buffer_load_dword v192, v9, s[28:31], s46 offen offset:0
  buffer_load_dword v196, v9, s[28:31], s46 offen offset:64
  buffer_load_dword v200, v9, s[28:31], s46 offen offset:128
  buffer_load_dword v204, v9, s[28:31], s46 offen offset:192
  buffer_load_dwordx4 a[16:19], v4, s[28:31], s38 offen offset:0
  buffer_load_dwordx4 a[20:23], v4, s[28:31], s38 offen offset:1024
  buffer_load_dwordx4 a[24:27], v4, s[28:31], s38 offen offset:2048
  buffer_load_dwordx4 a[28:31], v4, s[28:31], s38 offen offset:3072
  s_add_u32 s38, s38, 4096
  buffer_load_dwordx4 a[32:35], v4, s[28:31], s38 offen offset:0
  buffer_load_dwordx4 a[36:39], v4, s[28:31], s38 offen offset:1024
  buffer_load_dwordx4 a[40:43], v4, s[28:31], s38 offen offset:2048
  buffer_load_dwordx4 a[44:47], v4, s[28:31], s38 offen offset:3072
  s_add_u32 s38, s38, 4096
  buffer_load_dwordx4 a[48:51], v4, s[28:31], s38 offen offset:0
  buffer_load_dwordx4 a[52:55], v4, s[28:31], s38 offen offset:1024
  buffer_load_dwordx4 a[56:59], v4, s[28:31], s38 offen offset:2048
  buffer_load_dwordx4 a[60:63], v4, s[28:31], s38 offen offset:3072
  s_mov_b32 s24, s14
  s_and_b32 s25, s15, 0xffff
  s_mov_b32 s26, 25000
  s_mov_b32 s27, 0x20000
  s_add_u32 s16, s12, 8385536
  s_addc_u32 s17, s13, 0
  s_mov_b32 s20, s16
  s_and_b32 s21, s17, 0xffff
  s_mov_b32 s22, 3345408
  s_mov_b32 s23, 0x20000
  v_lshrrev_b32 v9, 2, v1
  v_bfe_u32 v10, v1, 1, 1
  v_mul_u32_u24 v11, 12, v10
  v_xor_b32 v9, v9, v11
  v_lshlrev_b32 v9, 4, v9
  v_lshl_add_u32 v9, v10, 8, v9
  v_and_b32 v10, 1, v1
  v_lshl_add_u32 v6, v10, 3, v9
  s_mul_i32 s49, s33, 5632
  s_add_u32 s49, s49, 131072
  s_lshl_b32 s32, s33, 14
  s_add_u32 s32, s32, 65536
  s_mov_b32 s55, 256
  s_mov_b32 s57, 0x40004000
  s_mov_b32 s58, 0x07060302
  s_mov_b32 s60, 12582912
  s_lshr_b32 s56, s37, 2
  s_mul_i32 s56, s56, 17408
  s_mul_i32 s46, s34, 4194304
  s_add_u32 s56, s56, s46
  s_add_u32 s56, s56, 16777216
  s_lshl_b32 s78, s35, 9
  s_add_u32 s78, s78, 59899904
  s_lshl_b32 s73, s35, 8
  s_add_u32 s73, s73, 59768832
  v_lshlrev_b32 v13, 5, v2
  v_add_u32 v13, s49, v13
  s_branch Lk2_run1
Lk2_run:
  s_lshl_b32 s40, s70, 14
  s_add_u32 s40, s40, s39
  s_lshl_b32 s41, s33, 12
  s_mov_b32 m0, s41
  s_nop 0
  buffer_load_dwordx4 v242, s[28:31], s40 offen offset:0 lds
  s_add_u32 m0, m0, 960
  s_nop 0
  buffer_load_dwordx4 v242, s[28:31], s40 offen offset:64 lds
  s_add_u32 m0, m0, 960
  s_nop 0
  buffer_load_dwordx4 v242, s[28:31], s40 offen offset:128 lds
  s_add_u32 m0, m0, 960
  s_nop 0
  buffer_load_dwordx4 v242, s[28:31], s40 offen offset:192 lds
  s_add_u32 s40, s40, 16384
  s_add_u32 s41, s41, 16384
  s_add_u32 s46, s70, 2
  s_lshl_b32 s46, s46, 14
  s_add_u32 s46, s46, s39
  s_lshl_b32 s47, s33, 12
  s_add_u32 m0, s47, 32768
  s_nop 0
  buffer_load_dwordx4 v242, s[28:31], s46 offen offset:0 lds
  s_add_u32 m0, m0, 960
  s_nop 0
  buffer_load_dwordx4 v242, s[28:31], s46 offen offset:64 lds
  s_add_u32 m0, m0, 960
  s_nop 0
  buffer_load_dwordx4 v242, s[28:31], s46 offen offset:128 lds
  s_add_u32 m0, m0, 960
  s_nop 0
  buffer_load_dwordx4 v242, s[28:31], s46 offen offset:192 lds
Lk2_run1:
  s_mov_b32 m0, s41
  s_nop 0
  buffer_load_dwordx4 v242, s[28:31], s40 offen offset:0 lds
  s_add_u32 m0, m0, 960
  s_nop 0
  buffer_load_dwordx4 v242, s[28:31], s40 offen offset:64 lds
  s_add_u32 m0, m0, 960
  s_nop 0
  buffer_load_dwordx4 v242, s[28:31], s40 offen offset:128 lds
  s_add_u32 m0, m0, 960
  s_nop 0
  buffer_load_dwordx4 v242, s[28:31], s40 offen offset:192 lds
  s_add_u32 s40, s40, 16384
  s_add_u32 s41, s41, 16384
  s_add_u32 s40, s40, 16384
  s_add_u32 s41, s41, 16384
  v_mov_b32 v12, 0x7fff0000
  s_mov_b32 s54, s32
  s_add_u32 s65, s32, 4096
  s_mov_b32 s67, 0
  s_mov_b32 m0, s54
  v_mov_b32 v228, 0
  v_mov_b32 v229, 0
  v_mov_b32 v230, 0
  v_mov_b32 v231, 0
  v_mov_b32 v232, 0
  v_mov_b32 v233, 0
  v_mov_b32 v234, 0
  v_mov_b32 v235, 0
  v_mfma_f32_32x32x16_bf16 v[16:31], v[228:231], v[228:231], 0
  v_mfma_f32_32x32x16_bf16 v[32:47], v[228:231], v[228:231], 0
  v_mfma_f32_32x32x16_bf16 v[48:63], v[228:231], v[228:231], 0
  v_mfma_f32_32x32x16_bf16 v[64:79], v[228:231], v[228:231], 0
  v_mfma_f32_32x32x16_bf16 v[80:95], v[228:231], v[228:231], 0
  v_mfma_f32_32x32x16_bf16 v[96:111], v[228:231], v[228:231], 0
  v_mfma_f32_32x32x16_bf16 v[112:127], v[228:231], v[228:231], 0
  v_mfma_f32_32x32x16_bf16 v[128:143], v[228:231], v[228:231], 0
  v_mfma_f32_32x32x16_bf16 v[144:159], v[228:231], v[228:231], 0
  v_mfma_f32_32x32x16_bf16 v[160:175], v[228:231], v[228:231], 0
  v_mfma_f32_32x32x16_bf16 v[176:191], v[228:231], v[228:231], 0
  v_mfma_f32_32x32x16_bf16 a[128:143], v[228:231], v[228:231], 0
  v_mfma_f32_32x32x16_bf16 a[144:159], v[228:231], v[228:231], 0
  v_mfma_f32_32x32x16_bf16 a[160:175], v[228:231], v[228:231], 0
  v_mfma_f32_32x32x16_bf16 a[176:191], v[228:231], v[228:231], 0
  v_and_b32 v9, 1, v2
  v_lshlrev_b32 v9, 3, v9
  v_xor_b32 v10, v9, v3
  v_lshlrev_b32 v10, 4, v10
  v_xor_b32 v216, 0, v10
  v_add_u32 v216, 3072, v216
  v_xor_b32 v217, 32, v10
  v_add_u32 v217, 2048, v217
  v_xor_b32 v218, 64, v10
  v_add_u32 v218, 1024, v218
  v_xor_b32 v219, 96, v10
  v_add_u32 v219, 0, v219
  v_bfe_u32 v10, v1, 2, 2
  v_lshl_add_u32 v11, v10, 2, v2
  v_lshlrev_b32 v11, 8, v11
  v_lshlrev_b32 v10, 1, v10
  v_xor_b32 v9, v9, v10
  v_bfe_u32 v10, v1, 1, 1
  v_xor_b32 v9, v9, v10
  v_lshl_add_u32 v11, v9, 4, v11
  v_and_b32 v10, 1, v1
  v_lshl_add_u32 v11, v10, 3, v11
  v_add_u32 v11, s54, v11
  v_xor_b32 v220, 0, v11
  v_xor_b32 v221, 32, v11
  v_xor_b32 v222, 64, v11
  v_xor_b32 v223, 96, v11
  v_xor_b32 v224, 128, v11
  v_xor_b32 v225, 160, v11
  v_xor_b32 v226, 192, v11
  v_xor_b32 v227, 224, v11
  v_add_u32 v15, 18, v3
  v_mov_b32 v248, v12
  v_mov_b32 v249, v12
  v_mov_b32 v250, v12
  v_mov_b32 v251, v12
  v_mov_b32 v252, v12
  v_mov_b32 v253, v12
  v_mov_b32 v254, v12
  v_mov_b32 v255, v12
  v_mov_b32 v7, v5
  s_mov_b32 s42, 0
  s_mov_b32 s43, 0
  s_mov_b32 s68, 0
  s_add_u32 s46, s70, 0x40004
  v_mov_b32 v236, s46
  v_mov_b32 v244, 0
  v_mov_b32 v245, 0
  v_mov_b32 v246, v12
  v_cmp_eq_u32 vcc, 0, v1
  v_mov_b32 v9, 153660
  s_mov_b32 s44, 4
  v_cndmask_b32 v247, v12, v9, vcc
  s_cmp_lg_u32 s45, 0
  s_cbranch_scc1 Lk2_second
  v_mfma_f32_32x32x16_bf16 a[192:207], v[228:231], v[228:231], 0
  v_mfma_f32_32x32x16_bf16 a[208:223], v[228:231], v[228:231], 0
  s_lshl_b32 s46, s36, 5
  v_lshlrev_b32 v10, 1, v3
  buffer_load_ushort v241, v10, s[24:27], s46 offen
  v_cmp_eq_u32 vcc, 0, v0
  v_mov_b32 v9, s73
  s_add_u32 s46, s70, 5
  v_cndmask_b32 v246, v12, v9, vcc
  v_cndmask_b32 v245, 0, 1, vcc
  v_mov_b32 v9, 30
  v_mov_b32 v10, s46
  v_cndmask_b32 v9, v9, v10, vcc
  v_lshlrev_b32 v10, 2, v0
  v_add_u32 v10, 153664, v10
  ds_write_b32 v10, v9
  s_mov_b32 s71, 1
  s_waitcnt vmcnt(29)
  s_cmp_lt_u32 s36, 782
  s_cselect_b32 s46, 1667, 0
  v_sub_u32 v239, v239, v238
  v_lshrrev_b32 v239, 2, v239
  v_min_u32 v239, s46, v239
  v_cmp_gt_u32 vcc, 60, v1
  s_nop 1
  v_cndmask_b32 v239, 0, v239, vcc
  v_mul_u32_u24 v9, 40960, v1
  v_mov_b32 v240, v239
  v_lshl_add_u32 v238, v238, 2, v9
  v_mov_b32 v232, 47251456
  v_add_u32_dpp v240, v240, v240 row_shr:1 row_mask:0xf bank_mask:0xf
  v_mov_b32 v233, v232
  v_mov_b32 v234, v232
  v_add_u32_dpp v240, v240, v240 row_shr:2 row_mask:0xf bank_mask:0xf
  v_mov_b32 v235, v232
  v_add_u32 v11, s49, v4
  v_add_u32_dpp v240, v240, v240 row_shr:4 row_mask:0xf bank_mask:0xf
  ds_write_b128 v11, v[232:235] offset:4096
  v_cmp_lt_u32 vcc, 8, v239
  v_add_u32_dpp v240, v240, v240 row_shr:8 row_mask:0xf bank_mask:0xf
  v_add_u32 v249, 16, v238
  v_add_u32 v250, 32, v238
  v_add_u32_dpp v240, v240, v240 row_bcast:15 row_mask:0xa bank_mask:0xf
  v_add_u32 v251, 48, v238
  v_add_u32 v252, 64, v238
  v_add_u32_dpp v240, v240, v240 row_bcast:31 row_mask:0xc bank_mask:0xf
  v_add_u32 v253, 80, v238
  v_add_u32 v254, 96, v238
  v_add_u32 v255, 112, v238
  v_mov_b32 v10, 1320
  v_readlane_b32 s59, v240, 63
  v_sub_u32 v240, v240, v239
  s_cmp_gt_u32 s59, 240
  s_cselect_b32 s46, 1, 0
  s_cmp_lg_u64 vcc, 0
  s_cselect_b32 s46, 1, s46
  s_cmp_eq_u32 s46, 0
  s_cselect_b32 s61, -1, 0
  s_cselect_b32 s59, s59, 0
  v_and_b32 v11, s61, v239
  v_lshlrev_b32 v9, 2, v240
  v_cmp_eq_u32 vcc, 0, v11
  s_add_u32 s66, s59, 7
  s_lshr_b32 s66, s66, 3
  v_cndmask_b32 v9, v9, v10, vcc
  v_add_u32 v9, s49, v9
  ds_write_b32 v9, v255 offset:4124
  ds_write_b32 v9, v254 offset:4120
  ds_write_b32 v9, v253 offset:4116
  ds_write_b32 v9, v252 offset:4112
  ds_write_b32 v9, v251 offset:4108
  ds_write_b32 v9, v250 offset:4104
  ds_write_b32 v9, v249 offset:4100
  ds_write_b32 v9, v238 offset:4096
  s_lshl_b32 s46, s59, 2
  v_lshlrev_b32 v9, 2, v1
  v_add_u32 v9, s49, v9
  v_add_u32 v11, s46, v9
  ds_write_b32 v11, v232 offset:4096
  s_mov_b32 m0, s49
  ds_read_b32 v248, v9 offset:4096
  ds_read_b32 v249, v9 offset:4352
  ds_read_b32 v250, v9 offset:4608
  ds_read_b32 v251, v9 offset:4864
  s_waitcnt lgkmcnt(3)
  buffer_load_dwordx4 v248, s[28:31], s60 offen lds
  s_add_u32 m0, m0, 1024
  s_waitcnt lgkmcnt(2)
  buffer_load_dwordx4 v249, s[28:31], s60 offen lds
  s_add_u32 m0, m0, 1024
  s_waitcnt lgkmcnt(1)
  buffer_load_dwordx4 v250, s[28:31], s60 offen lds
  s_add_u32 m0, m0, 1024
  s_waitcnt lgkmcnt(0)
  buffer_load_dwordx4 v251, s[28:31], s60 offen lds
  v_mov_b32 v248, v12
  v_mov_b32 v249, v12
  v_mov_b32 v250, v12
  v_mov_b32 v251, v12
  v_mov_b32 v252, v12
  v_mov_b32 v253, v12
  v_mov_b32 v254, v12
  v_mov_b32 v255, v12
  v_mov_b32 v232, 0
  v_mov_b32 v233, 0
  v_mov_b32 v234, 0
  v_mov_b32 v235, 0
  s_waitcnt vmcnt(21)
  s_branch Lk2_go
Lk2_second:
  v_lshlrev_b32 v10, 2, v0
  v_add_u32 v10, 153664, v10
  ds_read_b32 v9, v10
  s_waitcnt lgkmcnt(0)
  v_and_b32 v9, 0xffff, v9
  ds_write_b32 v10, v9
  s_waitcnt vmcnt(0)
Lk2_go:
  s_mov_b32 s47, 0x40000
  s_mov_b32 s48, 0x10000
  s_mov_b32 s63, 0
  s_lshl_b32 s64, s66, 7
  s_add_u32 s72, s66, 1
  s_add_u32 s62, s66, 2
  s_cmp_eq_u32 s66, 0
  s_cselect_b32 s72, 0, s72
  s_cselect_b32 s62, 0, s62
  s_mov_b32 s63, -128
  s_waitcnt lgkmcnt(0)
  s_barrier
  ds_read_b128 a[64:67], v7 offset:0
  ds_read_b128 a[68:71], v7 offset:1024
  ds_read_b128 a[72:75], v7 offset:2048
  ds_read_b128 a[76:79], v7 offset:3072
  ds_read_b128 a[80:83], v7 offset:4096
  ds_read_b128 a[84:87], v7 offset:5120
  ds_read_b128 a[88:91], v7 offset:6144
  ds_read_b128 a[92:95], v7 offset:7168
  ds_read_b128 a[96:99], v7 offset:8192
  ds_read_b128 a[100:103], v7 offset:9216
  ds_read_b128 a[104:107], v7 offset:10240
  ds_read_b128 a[108:111], v7 offset:11264
  ds_read_b128 a[112:115], v7 offset:12288
  ds_read_b128 a[116:119], v7 offset:13312
  ds_read_b128 a[120:123], v7 offset:14336
  ds_read_b128 a[124:127], v7 offset:15360
  v_mov_b32 v193, v192
  v_mov_b32 v194, v192
  v_mov_b32 v195, v192
  v_mov_b32 v197, v196
  v_mov_b32 v198, v196
  v_mov_b32 v199, v196
  v_mov_b32 v201, v200
  v_mov_b32 v202, v200
  v_mov_b32 v203, v200
  v_mov_b32 v205, v204
  v_mov_b32 v206, v204
  v_mov_b32 v207, v204
  s_waitcnt lgkmcnt(4)
  s_branch Lk2_loop
Lk2_glue:
  s_cmp_le_u32 s71, 2
  s_cbranch_scc1 Lk2_glue12
  s_add_u32 s71, s71, 1
  s_add_u32 s67, s67, 1
  s_cmp_eq_u32 s67, 1
  s_cbranch_scc1 Lk2_glue_w1
  s_cmp_eq_u32 s67, 4
  s_cbranch_scc1 Lk2_glue_w3
  s_cmp_eq_u32 s67, 5
  s_cbranch_scc1 Lk2_glue_w4
  v_readfirstlane_b32 s46, v10
  s_nop 0
  s_cmp_lt_u32 s46, 16
  s_cbranch_scc1 Lk2_glue_w4
  s_sub_u32 s46, s67, 2
  s_lshl_b32 s46, s46, 13
  s_add_u32 s54, s32, s46
  s_add_u32 s65, s54, 4096
  s_add_u32 s46, s54, 3214336
  v_add_u32 v248, s46, v4
  v_add_u32 v252, 4096, v248
  v_mov_b32 v249, v248
  v_mov_b64 v[250:251], v[248:249]
  v_mov_b32 v253, v252
  v_mov_b64 v[254:255], v[252:253]
  s_branch Lk2_glue_back
Lk2_glue_w1:
  v_mov_b32 v9, 0
  s_mov_b32 s46, 59782912
  buffer_load_dword v10, v9, s[28:31], s46 offen sc1
  s_branch Lk2_glue_back
Lk2_glue_w3:
  v_mov_b32 v248, 0x7fff0000
  v_mov_b32 v249, v248
  v_mov_b64 v[250:251], v[248:249]
  v_mov_b64 v[252:253], v[248:249]
  v_mov_b64 v[254:255], v[248:249]
  v_mov_b64 v[220:221], v[248:249]
  v_mov_b64 v[222:223], v[248:249]
  v_mov_b64 v[224:225], v[248:249]
  v_mov_b64 v[226:227], v[248:249]
  v_mov_b32 v13, v248
  s_mov_b32 s54, 0x30000
  s_mov_b32 s65, 0x30000
  s_lshr_b32 s46, s33, 1
  s_lshl_b32 s46, s46, 12
  s_and_b32 s3, s33, 1
  s_lshl_b32 s4, s3, 11
  s_add_u32 s4, s4, s46
  s_add_u32 m0, s4, 154688
  s_lshl_b32 s3, s3, 7
  s_add_u32 s46, s46, s3
  s_add_u32 s46, s46, 11583488
  buffer_load_dwordx4 v242, s[28:31], s46 offen lds
  s_add_u32 m0, m0, 960
  s_min_u32 s3, s36, 783
  buffer_load_dwordx4 v242, s[28:31], s46 offen offset:64 lds
  s_mov_b32 m0, s49
  s_lshl_b32 s3, s3, 12
  s_add_u32 s3, s3, 4194304
  buffer_load_dwordx4 v4, s[28:31], s3 offen offset:0 lds
  buffer_load_dwordx4 v4, s[28:31], s3 offen offset:1024 lds
  buffer_load_dwordx4 v4, s[28:31], s3 offen offset:2048 lds
  buffer_load_dwordx4 v4, s[28:31], s3 offen offset:3072 lds
  s_branch Lk2_glue_back
Lk2_glue_w4:
  s_mov_b32 s71, 0
  s_getpc_b64 s[4:5]
Lpf1:
  s_add_u32 s4, s4, Lk2_endcode-Lpf1
  s_addc_u32 s5, s5, 0
  v_lshlrev_b32 v239, 7, v1
  global_load_dword v240, v239, s[4:5]
  s_branch Lk2_glue_back
Lk2_glue12:
  s_cmp_eq_u32 s71, 1
  s_cbranch_scc1 Lk2_glue1
  s_add_u32 s71, s66, 2
  s_max_u32 s71, s71, 10
  s_and_b32 s71, s71, s61
  s_barrier
  s_branch Lk2_glue_back
Lk2_glue1:
  s_add_u32 s46, s70, 2
  s_lshl_b32 s46, s46, 14
  s_add_u32 s46, s46, s39
  s_lshl_b32 s47, s33, 12
  s_add_u32 m0, s47, 32768
  s_nop 0
  buffer_load_dwordx4 v242, s[28:31], s46 offen offset:0 lds
  s_add_u32 m0, m0, 960
  s_nop 0
  buffer_load_dwordx4 v242, s[28:31], s46 offen offset:64 lds
  s_add_u32 m0, m0, 960
  s_nop 0
  buffer_load_dwordx4 v242, s[28:31], s46 offen offset:128 lds
  s_add_u32 m0, m0, 960
  s_nop 0
  buffer_load_dwordx4 v242, s[28:31], s46 offen offset:192 lds
  s_mov_b32 s71, 2
  s_mov_b32 s47, 0x40000
  s_barrier
  s_branch Lk2_glue_back
Lk2_sync:
  v_add_u32 v9, 0, v247
  s_mov_b32 s46, 0
Lk2_sync1:
  ds_read_b32 v236, v9
  s_add_u32 s46, s46, 1
  s_waitcnt lgkmcnt(0)
  v_readfirstlane_b32 s69, v236
  s_cmp_gt_u32 s46, 4194304
  s_cbranch_scc1 Lk2_sync_back
  s_cmp_lt_u32 s69, s47
  s_cbranch_scc1 Lk2_sync1
  s_branch Lk2_sync_back
.p2align 6
Lk2_loop:
  v_mfma_f32_16x16x32_bf16 v[144:147], a[64:67], a[0:3], v[192:195]
  s_mov_b32 m0, s41
  v_exp_f32 v156, v156
  v_mfma_f32_16x16x32_bf16 v[144:147], a[68:71], a[4:7], v[144:147]
  v_add_u32 v8, s43, v6
  v_readfirstlane_b32 s69, v236
  v_mfma_f32_16x16x32_bf16 v[144:147], a[72:75], a[8:11], v[144:147]
  v_exp_f32 v157, v157
  v_mfma_f32_16x16x32_bf16 v[144:147], a[76:79], a[12:15], v[144:147]
  s_cmp_lt_u32 s69, s47
  v_cvt_pk_bf16_f32 v189, v154, v155
  v_cvt_pk_bf16_f32 v190, v156, v157
  v_mfma_f32_16x16x32_bf16 v[104:107], a[176:179], v[176:179], v[104:107]
  s_cbranch_scc1 Lk2_sync
Lk2_sync_back:
  v_exp_f32 v158, v158
  v_mfma_f32_16x16x32_bf16 v[104:107], a[180:183], v[180:183], v[104:107]
  buffer_load_dwordx4 v242, s[28:31], s40 offen offset:0 lds
  v_add_u32 v14, s63, v13
  v_mfma_f32_16x16x32_bf16 v[108:111], a[184:187], v[176:179], v[108:111]
  s_add_u32 m0, m0, 960
  v_exp_f32 v159, v159
  v_mfma_f32_16x16x32_bf16 v[108:111], a[188:191], v[180:183], v[108:111]
  buffer_load_dwordx4 v242, s[28:31], s40 offen offset:64 lds
  v_cvt_pk_bf16_f32 v191, v158, v159
  v_mfma_f32_16x16x32_bf16 v[148:151], a[80:83], a[0:3], v[192:195]
  s_add_u32 m0, m0, 960
  v_exp_f32 v144, v144
  v_mfma_f32_16x16x32_bf16 v[148:151], a[84:87], a[4:7], v[148:151]
  s_sub_u32 s69, s69, s47
  buffer_load_dwordx4 v242, s[28:31], s40 offen offset:128 lds
  v_add_u32 v247, 4, v247
  v_mfma_f32_16x16x32_bf16 v[148:151], a[88:91], a[8:11], v[148:151]
  s_add_u32 m0, m0, 960
  v_exp_f32 v145, v145
  v_mfma_f32_16x16x32_bf16 v[148:151], a[92:95], a[12:15], v[148:151]
  s_cmp_lt_u32 s68, 200
  buffer_load_dwordx4 v242, s[28:31], s40 offen offset:192 lds
  v_cvt_pk_bf16_f32 v160, v144, v145
  v_mfma_f32_16x16x32_bf16 v[112:115], a[128:131], v[184:187], v[112:115]
  v_exp_f32 v146, v146
  v_mfma_f32_16x16x32_bf16 v[112:115], a[132:135], v[188:191], v[112:115]
  s_cselect_b32 s69, s69, 0xff
  ds_read_b64_tr_b16 a[128:129], v8 offset:0
  ds_read_b64_tr_b16 a[130:131], v8 offset:4096
  v_mfma_f32_16x16x32_bf16 v[116:119], a[136:139], v[184:187], v[116:119]
  s_min_u32 s69, s69, 195
  v_exp_f32 v147, v147
  v_mfma_f32_16x16x32_bf16 v[116:119], a[140:143], v[188:191], v[116:119]
  ds_read_b64_tr_b16 a[132:133], v8 offset:8192
  v_cvt_pk_bf16_f32 v161, v146, v147
  v_mfma_f32_16x16x32_bf16 v[152:155], a[96:99], a[0:3], v[192:195]
  s_lshl_b32 s40, s69, 14
  v_exp_f32 v148, v148
  v_mfma_f32_16x16x32_bf16 v[152:155], a[100:103], a[4:7], v[152:155]
  ds_read_b64_tr_b16 a[134:135], v8 offset:12288
  ds_read_b64_tr_b16 a[136:137], v8 offset:512
  v_mfma_f32_16x16x32_bf16 v[152:155], a[104:107], a[8:11], v[152:155]
  s_add_u32 s41, s41, 16384
  v_exp_f32 v149, v149
  v_mfma_f32_16x16x32_bf16 v[152:155], a[108:111], a[12:15], v[152:155]
  ds_read_b64_tr_b16 a[138:139], v8 offset:4608
  v_cvt_pk_bf16_f32 v162, v148, v149
  v_mfma_f32_16x16x32_bf16 v[120:123], a[144:147], v[184:187], v[120:123]
  s_add_u32 s40, s40, s39
  v_exp_f32 v150, v150
  v_mfma_f32_16x16x32_bf16 v[120:123], a[148:151], v[188:191], v[120:123]
  ds_read_b64_tr_b16 a[140:141], v8 offset:8704
  ds_read_b64_tr_b16 a[142:143], v8 offset:12800
  v_mfma_f32_16x16x32_bf16 v[124:127], a[152:155], v[184:187], v[124:127]
  v_exp_f32 v151, v151
  v_mfma_f32_16x16x32_bf16 v[124:127], a[156:159], v[188:191], v[124:127]
  s_waitcnt lgkmcnt(5)
  ds_read_b64_tr_b16 a[144:145], v8 offset:1024
  v_cvt_pk_bf16_f32 v163, v150, v151
  v_mfma_f32_16x16x32_bf16 v[156:159], a[112:115], a[0:3], v[192:195]
  s_and_b32 s41, s41, 0xffff
  v_exp_f32 v152, v152
  v_mfma_f32_16x16x32_bf16 v[156:159], a[116:119], a[4:7], v[156:159]
  ds_read_b64_tr_b16 a[146:147], v8 offset:5120
  ds_read_b64_tr_b16 a[148:149], v8 offset:9216
  v_mfma_f32_16x16x32_bf16 v[156:159], a[120:123], a[8:11], v[156:159]
  v_exp_f32 v153, v153
  v_mfma_f32_16x16x32_bf16 v[156:159], a[124:127], a[12:15], v[156:159]
  ds_read_b64_tr_b16 a[150:151], v8 offset:13312
  v_cvt_pk_bf16_f32 v164, v152, v153
  v_mfma_f32_16x16x32_bf16 v[128:131], a[160:163], v[184:187], v[128:131]
  s_cmp_lt_u32 s69, 195
  v_exp_f32 v154, v154
  v_mfma_f32_16x16x32_bf16 v[128:131], a[164:167], v[188:191], v[128:131]
  ds_read_b64_tr_b16 a[152:153], v8 offset:1536
  ds_read_b64_tr_b16 a[154:155], v8 offset:5632
  v_mfma_f32_16x16x32_bf16 v[132:135], a[168:171], v[184:187], v[132:135]
  v_exp_f32 v155, v155
  v_mfma_f32_16x16x32_bf16 v[132:135], a[172:175], v[188:191], v[132:135]
  s_waitcnt vmcnt(21)
  ds_read_b64_tr_b16 a[156:157], v8 offset:9728
  v_cvt_pk_bf16_f32 v165, v154, v155
  v_mfma_f32_16x16x32_bf16 v[144:147], a[64:67], a[16:19], v[196:199]
  s_addc_u32 s44, s44, 0
  v_exp_f32 v156, v156
  v_mfma_f32_16x16x32_bf16 v[144:147], a[68:71], a[20:23], v[144:147]
  ds_read_b64_tr_b16 a[158:159], v8 offset:13824
  ds_read_b64_tr_b16 a[160:161], v8 offset:2048
  v_mfma_f32_16x16x32_bf16 v[144:147], a[72:75], a[24:27], v[144:147]
  v_exp_f32 v157, v157
  v_mfma_f32_16x16x32_bf16 v[144:147], a[76:79], a[28:31], v[144:147]
  ds_read_b64_tr_b16 a[162:163], v8 offset:6144
  v_cvt_pk_bf16_f32 v166, v156, v157
  v_mfma_f32_16x16x32_bf16 v[136:139], a[176:179], v[184:187], v[136:139]
  v_exp_f32 v158, v158
  v_mfma_f32_16x16x32_bf16 v[136:139], a[180:183], v[188:191], v[136:139]
  ds_read_b64_tr_b16 a[164:165], v8 offset:10240
  ds_read_b64_tr_b16 a[166:167], v8 offset:14336
  v_mfma_f32_16x16x32_bf16 v[140:143], a[184:187], v[184:187], v[140:143]
  v_exp_f32 v159, v159
  v_mfma_f32_16x16x32_bf16 v[140:143], a[188:191], v[188:191], v[140:143]
  ds_read_b64_tr_b16 a[168:169], v8 offset:2560
  v_cvt_pk_bf16_f32 v167, v158, v159
  v_mfma_f32_16x16x32_bf16 v[148:151], a[80:83], a[16:19], v[196:199]
  s_add_u32 s68, s68, 1
  v_exp_f32 v144, v144
  v_mfma_f32_16x16x32_bf16 v[148:151], a[84:87], a[20:23], v[148:151]
  ds_read_b64_tr_b16 a[170:171], v8 offset:6656
  ds_read_b64_tr_b16 a[172:173], v8 offset:10752
  v_mfma_f32_16x16x32_bf16 v[148:151], a[88:91], a[24:27], v[148:151]
  v_exp_f32 v145, v145
  v_mfma_f32_16x16x32_bf16 v[148:151], a[92:95], a[28:31], v[148:151]
  ds_read_b64_tr_b16 a[174:175], v8 offset:14848
  v_cvt_pk_bf16_f32 v168, v144, v145
  v_mfma_f32_16x16x32_bf16 v[16:19], a[128:131], v[160:163], v[16:19]
  s_waitcnt lgkmcnt(4)
  v_exp_f32 v146, v146
  v_mfma_f32_16x16x32_bf16 v[16:19], a[132:135], v[164:167], v[16:19]
  ds_read_b64_tr_b16 a[176:177], v8 offset:3072
  ds_read_b64_tr_b16 a[178:179], v8 offset:7168
  v_mfma_f32_16x16x32_bf16 v[20:23], a[136:139], v[160:163], v[20:23]
  v_exp_f32 v147, v147
  v_mfma_f32_16x16x32_bf16 v[20:23], a[140:143], v[164:167], v[20:23]
  ds_read_b64_tr_b16 a[180:181], v8 offset:11264
  v_cvt_pk_bf16_f32 v169, v146, v147
  v_mfma_f32_16x16x32_bf16 v[152:155], a[96:99], a[16:19], v[196:199]
  v_exp_f32 v148, v148
  v_mfma_f32_16x16x32_bf16 v[152:155], a[100:103], a[20:23], v[152:155]
  ds_read_b64_tr_b16 a[182:183], v8 offset:15360
  ds_read_b64_tr_b16 a[184:185], v8 offset:3584
  v_mfma_f32_16x16x32_bf16 v[152:155], a[104:107], a[24:27], v[152:155]
  s_add_u32 s42, s42, 16384
  v_exp_f32 v149, v149
  v_mfma_f32_16x16x32_bf16 v[152:155], a[108:111], a[28:31], v[152:155]
  ds_read_b64_tr_b16 a[186:187], v8 offset:7680
  v_cvt_pk_bf16_f32 v170, v148, v149
  v_mfma_f32_16x16x32_bf16 v[24:27], a[144:147], v[160:163], v[24:27]
  v_exp_f32 v150, v150
  v_mfma_f32_16x16x32_bf16 v[24:27], a[148:151], v[164:167], v[24:27]
  ds_read_b64_tr_b16 a[188:189], v8 offset:11776
  ds_read_b64_tr_b16 a[190:191], v8 offset:15872
  v_mfma_f32_16x16x32_bf16 v[28:31], a[152:155], v[160:163], v[28:31]
  s_and_b32 s42, s42, 0xffff
  v_exp_f32 v151, v151
  v_mfma_f32_16x16x32_bf16 v[28:31], a[156:159], v[164:167], v[28:31]
  v_cvt_pk_bf16_f32 v171, v150, v151
  v_mfma_f32_16x16x32_bf16 v[156:159], a[112:115], a[16:19], v[196:199]
  v_exp_f32 v152, v152
  v_mfma_f32_16x16x32_bf16 v[156:159], a[116:119], a[20:23], v[156:159]
  s_waitcnt vmcnt(8)
  ds_read_b128 v[208:211], v14
  ds_read_b128 v[212:215], v14 offset:16
  v_mfma_f32_16x16x32_bf16 v[156:159], a[120:123], a[24:27], v[156:159]
  s_add_u32 s63, s63, 128
  v_exp_f32 v153, v153
  v_mfma_f32_16x16x32_bf16 v[156:159], a[124:127], a[28:31], v[156:159]
  ds_read_b64_tr_b16 a[224:225], v220 offset:0
  v_cvt_pk_bf16_f32 v172, v152, v153
  v_mfma_f32_16x16x32_bf16 v[32:35], a[160:163], v[160:163], v[32:35]
  v_exp_f32 v154, v154
  v_mfma_f32_16x16x32_bf16 v[32:35], a[164:167], v[164:167], v[32:35]
  s_waitcnt lgkmcnt(3)
  ds_read_b64_tr_b16 a[228:229], v221 offset:0
  ds_read_b64_tr_b16 a[232:233], v222 offset:0
  v_mfma_f32_16x16x32_bf16 v[36:39], a[168:171], v[160:163], v[36:39]
  s_min_u32 s63, s63, s64
  v_exp_f32 v155, v155
  v_mfma_f32_16x16x32_bf16 v[36:39], a[172:175], v[164:167], v[36:39]
  ds_read_b64_tr_b16 a[236:237], v223 offset:0
  v_cvt_pk_bf16_f32 v173, v154, v155
  v_mfma_f32_16x16x32_bf16 v[144:147], a[64:67], a[32:35], v[200:203]
  v_exp_f32 v156, v156
  v_mfma_f32_16x16x32_bf16 v[144:147], a[68:71], a[36:39], v[144:147]
  s_cmp_eq_u32 s71, s68
  ds_read_b64_tr_b16 a[240:241], v224 offset:0
  ds_read_b64_tr_b16 a[244:245], v225 offset:0
  v_mfma_f32_16x16x32_bf16 v[144:147], a[72:75], a[40:43], v[144:147]
  v_exp_f32 v157, v157
  v_mfma_f32_16x16x32_bf16 v[144:147], a[76:79], a[44:47], v[144:147]
  ds_read_b64_tr_b16 a[248:249], v226 offset:0
  v_cvt_pk_bf16_f32 v174, v156, v157
  v_mfma_f32_16x16x32_bf16 v[40:43], a[176:179], v[160:163], v[40:43]
  s_waitcnt vmcnt(4)
  v_exp_f32 v158, v158
  v_mfma_f32_16x16x32_bf16 v[40:43], a[180:183], v[164:167], v[40:43]
  s_cbranch_scc1 Lk2_glue
Lk2_glue_back:
  ds_read_b64_tr_b16 a[252:253], v227 offset:0
  ds_read_b64_tr_b16 a[226:227], v220 offset:4096
  v_mfma_f32_16x16x32_bf16 v[44:47], a[184:187], v[160:163], v[44:47]
  v_exp_f32 v159, v159
  v_mfma_f32_16x16x32_bf16 v[44:47], a[188:191], v[164:167], v[44:47]
  s_mov_b32 m0, s54
  ds_read_b64_tr_b16 a[230:231], v221 offset:4096
  v_cvt_pk_bf16_f32 v175, v158, v159
  v_mfma_f32_16x16x32_bf16 v[148:151], a[80:83], a[32:35], v[200:203]
  v_exp_f32 v144, v144
  v_mfma_f32_16x16x32_bf16 v[148:151], a[84:87], a[36:39], v[148:151]
  ds_read_b64_tr_b16 a[234:235], v222 offset:4096
  ds_read_b64_tr_b16 a[238:239], v223 offset:4096
  v_mfma_f32_16x16x32_bf16 v[148:151], a[88:91], a[40:43], v[148:151]
  v_exp_f32 v145, v145
  v_mfma_f32_16x16x32_bf16 v[148:151], a[92:95], a[44:47], v[148:151]
  ds_read_b64_tr_b16 a[242:243], v224 offset:4096
  v_cvt_pk_bf16_f32 v176, v144, v145
  v_mfma_f32_16x16x32_bf16 v[48:51], a[128:131], v[168:171], v[48:51]
  v_exp_f32 v146, v146
  v_mfma_f32_16x16x32_bf16 v[48:51], a[132:135], v[172:175], v[48:51]
  s_sub_u32 s62, s62, 1
  ds_read_b64_tr_b16 a[246:247], v225 offset:4096
  ds_read_b64_tr_b16 a[250:251], v226 offset:4096
  v_mfma_f32_16x16x32_bf16 v[52:55], a[136:139], v[168:171], v[52:55]
  v_exp_f32 v147, v147
  v_mfma_f32_16x16x32_bf16 v[52:55], a[140:143], v[172:175], v[52:55]
  ds_read_b64_tr_b16 a[254:255], v227 offset:4096
  v_cvt_pk_bf16_f32 v177, v146, v147
  v_mfma_f32_16x16x32_bf16 v[152:155], a[96:99], a[32:35], v[200:203]
  s_cmp_lt_u32 s62, s72
  v_exp_f32 v148, v148
  v_mfma_f32_16x16x32_bf16 v[152:155], a[100:103], a[36:39], v[152:155]
  v_or_b32 v244, s48, v244
  v_add_u32 v7, s42, v5
  v_mfma_f32_16x16x32_bf16 v[152:155], a[104:107], a[40:43], v[152:155]
  v_exp_f32 v149, v149
  v_mfma_f32_16x16x32_bf16 v[152:155], a[108:111], a[44:47], v[152:155]
  ds_add_u32 v247, v244
  v_cvt_pk_bf16_f32 v178, v148, v149
  v_mfma_f32_16x16x32_bf16 v[56:59], a[144:147], v[168:171], v[56:59]
  s_waitcnt lgkmcnt(1)
  v_exp_f32 v150, v150
  v_mfma_f32_16x16x32_bf16 v[56:59], a[148:151], v[172:175], v[56:59]
  s_cbranch_scc0 Lk2_gskip
  v_mad_u32_u16 v248, v208, s55, v216
  v_mad_u32_u16 v249, v209, s55, v217
  v_mfma_f32_16x16x32_bf16 a[192:195], a[224:227], v[228:231], a[192:195]
  v_mad_u32_u16 v250, v210, s55, v218
  v_mad_u32_u16 v251, v211, s55, v219
  v_mfma_f32_16x16x32_bf16 a[196:199], a[228:231], v[228:231], a[196:199]
  v_mad_u32_u16 v252, v212, s55, v216
  v_mad_u32_u16 v253, v213, s55, v217
  v_mfma_f32_16x16x32_bf16 a[200:203], a[232:235], v[228:231], a[200:203]
  v_mad_u32_u16 v254, v214, s55, v218
  v_mad_u32_u16 v255, v215, s55, v219
  v_mfma_f32_16x16x32_bf16 a[204:207], a[236:239], v[228:231], a[204:207]
  v_perm_b32 v232, v209, v208, s58
  v_perm_b32 v233, v211, v210, s58
  v_mfma_f32_16x16x32_bf16 a[208:211], a[240:243], v[228:231], a[208:211]
  v_perm_b32 v234, v213, v212, s58
  v_perm_b32 v235, v215, v214, s58
  v_mfma_f32_16x16x32_bf16 a[212:215], a[244:247], v[228:231], a[212:215]
  v_alignbit_b32 v232, v232, v232, v15
  v_alignbit_b32 v233, v233, v233, v15
  v_mfma_f32_16x16x32_bf16 a[216:219], a[248:251], v[228:231], a[216:219]
  v_alignbit_b32 v234, v234, v234, v15
  v_alignbit_b32 v235, v235, v235, v15
  v_mfma_f32_16x16x32_bf16 a[220:223], a[252:255], v[228:231], a[220:223]
  v_and_b32 v228, s57, v232
  v_and_b32 v229, s57, v233
Lk2_gskip:
  v_mfma_f32_16x16x32_bf16 v[60:63], a[152:155], v[168:171], v[60:63]
  v_exp_f32 v151, v151
  v_mfma_f32_16x16x32_bf16 v[60:63], a[156:159], v[172:175], v[60:63]
  buffer_load_dwordx4 v248, s[20:23], 0 offen offset:0 sc1 lds
  v_cvt_pk_bf16_f32 v179, v150, v151
  v_mfma_f32_16x16x32_bf16 v[156:159], a[112:115], a[32:35], v[200:203]
  v_exp_f32 v152, v152
  v_mfma_f32_16x16x32_bf16 v[156:159], a[116:119], a[36:39], v[156:159]
  v_mov_b32 v244, v245
  v_and_b32 v230, s57, v234
  v_mfma_f32_16x16x32_bf16 v[156:159], a[120:123], a[40:43], v[156:159]
  v_exp_f32 v153, v153
  v_mfma_f32_16x16x32_bf16 v[156:159], a[124:127], a[44:47], v[156:159]
  v_and_b32 v231, s57, v235
  v_cvt_pk_bf16_f32 v180, v152, v153
  v_mfma_f32_16x16x32_bf16 v[64:67], a[160:163], v[168:171], v[64:67]
  v_exp_f32 v154, v154
  v_mfma_f32_16x16x32_bf16 v[64:67], a[164:167], v[172:175], v[64:67]
  buffer_load_dwordx4 v249, s[20:23], 0 offen offset:1024 sc1 lds
  v_mfma_f32_16x16x32_bf16 v[68:71], a[168:171], v[168:171], v[68:71]
  v_exp_f32 v155, v155
  v_mfma_f32_16x16x32_bf16 v[68:71], a[172:175], v[172:175], v[68:71]
  buffer_atomic_add v244, v246, s[28:31], 0 offen sc0
  v_cvt_pk_bf16_f32 v181, v154, v155
  v_mfma_f32_16x16x32_bf16 v[144:147], a[64:67], a[48:51], v[204:207]
  v_exp_f32 v156, v156
  v_mfma_f32_16x16x32_bf16 v[144:147], a[68:71], a[52:55], v[144:147]
  ds_read_b128 a[64:67], v7 offset:0
  ds_read_b128 a[68:71], v7 offset:1024
  v_mfma_f32_16x16x32_bf16 v[144:147], a[72:75], a[56:59], v[144:147]
  s_mov_b32 s43, s42
  v_exp_f32 v157, v157
  v_mfma_f32_16x16x32_bf16 v[144:147], a[76:79], a[60:63], v[144:147]
  buffer_load_dwordx4 v250, s[20:23], 0 offen offset:2048 sc1 lds
  v_cvt_pk_bf16_f32 v182, v156, v157
  v_mfma_f32_16x16x32_bf16 v[72:75], a[176:179], v[168:171], v[72:75]
  v_exp_f32 v158, v158
  v_mfma_f32_16x16x32_bf16 v[72:75], a[180:183], v[172:175], v[72:75]
  ds_read_b128 a[72:75], v7 offset:2048
  ds_read_b128 a[76:79], v7 offset:3072
  v_mfma_f32_16x16x32_bf16 v[76:79], a[184:187], v[168:171], v[76:79]
  v_exp_f32 v159, v159
  v_mfma_f32_16x16x32_bf16 v[76:79], a[188:191], v[172:175], v[76:79]
  buffer_load_dwordx4 v251, s[20:23], 0 offen offset:3072 sc1 lds
  v_cvt_pk_bf16_f32 v183, v158, v159
  v_mfma_f32_16x16x32_bf16 v[148:151], a[80:83], a[48:51], v[204:207]
  s_mov_b32 m0, s65
  v_exp_f32 v144, v144
  v_mfma_f32_16x16x32_bf16 v[148:151], a[84:87], a[52:55], v[148:151]
  ds_read_b128 a[80:83], v7 offset:4096
  ds_read_b128 a[84:87], v7 offset:5120
  v_mfma_f32_16x16x32_bf16 v[148:151], a[88:91], a[56:59], v[148:151]
  v_exp_f32 v145, v145
  v_mfma_f32_16x16x32_bf16 v[148:151], a[92:95], a[60:63], v[148:151]
  ds_read_b128 a[88:91], v7 offset:6144
  v_cvt_pk_bf16_f32 v184, v144, v145
  v_mfma_f32_16x16x32_bf16 v[80:83], a[128:131], v[176:179], v[80:83]
  v_exp_f32 v146, v146
  v_mfma_f32_16x16x32_bf16 v[80:83], a[132:135], v[180:183], v[80:83]
  buffer_load_dwordx4 v252, s[20:23], 0 offen offset:0 sc1 lds
  ds_read_b128 a[92:95], v7 offset:7168
  v_mfma_f32_16x16x32_bf16 v[84:87], a[136:139], v[176:179], v[84:87]
  v_exp_f32 v147, v147
  v_mfma_f32_16x16x32_bf16 v[84:87], a[140:143], v[180:183], v[84:87]
  ds_read_b32 v236, v247
  v_cvt_pk_bf16_f32 v185, v146, v147
  v_mfma_f32_16x16x32_bf16 v[152:155], a[96:99], a[48:51], v[204:207]
  v_exp_f32 v148, v148
  v_mfma_f32_16x16x32_bf16 v[152:155], a[100:103], a[52:55], v[152:155]
  ds_read_b128 a[96:99], v7 offset:8192
  ds_read_b128 a[100:103], v7 offset:9216
  v_mfma_f32_16x16x32_bf16 v[152:155], a[104:107], a[56:59], v[152:155]
  v_exp_f32 v149, v149
  v_mfma_f32_16x16x32_bf16 v[152:155], a[108:111], a[60:63], v[152:155]
  buffer_load_dwordx4 v253, s[20:23], 0 offen offset:1024 sc1 lds
  v_cvt_pk_bf16_f32 v186, v148, v149
  v_mfma_f32_16x16x32_bf16 v[88:91], a[144:147], v[176:179], v[88:91]
  v_exp_f32 v150, v150
  v_mfma_f32_16x16x32_bf16 v[88:91], a[148:151], v[180:183], v[88:91]
  ds_read_b128 a[104:107], v7 offset:10240
  ds_read_b128 a[108:111], v7 offset:11264
  v_mfma_f32_16x16x32_bf16 v[92:95], a[152:155], v[176:179], v[92:95]
  v_exp_f32 v151, v151
  v_mfma_f32_16x16x32_bf16 v[92:95], a[156:159], v[180:183], v[92:95]
  s_sub_u32 s44, s44, 1
  buffer_load_dwordx4 v254, s[20:23], 0 offen offset:2048 sc1 lds
  v_cvt_pk_bf16_f32 v187, v150, v151
  v_mfma_f32_16x16x32_bf16 v[156:159], a[112:115], a[48:51], v[204:207]
  v_exp_f32 v152, v152
  v_mfma_f32_16x16x32_bf16 v[156:159], a[116:119], a[52:55], v[156:159]
  ds_read_b128 a[112:115], v7 offset:12288
  ds_read_b128 a[116:119], v7 offset:13312
  v_mfma_f32_16x16x32_bf16 v[156:159], a[120:123], a[56:59], v[156:159]
  s_cmp_lg_u32 s44, 0
  v_exp_f32 v153, v153
  v_mfma_f32_16x16x32_bf16 v[156:159], a[124:127], a[60:63], v[156:159]
  ds_read_b128 a[120:123], v7 offset:14336
  v_cvt_pk_bf16_f32 v188, v152, v153
  v_mfma_f32_16x16x32_bf16 v[96:99], a[160:163], v[176:179], v[96:99]
  v_exp_f32 v154, v154
  v_mfma_f32_16x16x32_bf16 v[96:99], a[164:167], v[180:183], v[96:99]
  buffer_load_dwordx4 v255, s[20:23], 0 offen offset:3072 sc1 lds
  ds_read_b128 a[124:127], v7 offset:15360
  v_mfma_f32_16x16x32_bf16 v[100:103], a[168:171], v[176:179], v[100:103]
  v_exp_f32 v155, v155
  v_mfma_f32_16x16x32_bf16 v[100:103], a[172:175], v[180:183], v[100:103]
  s_waitcnt lgkmcnt(4)
  s_cbranch_scc1 Lk2_loop
Lk2_endcode:
  s_waitcnt lgkmcnt(0)
  s_cmp_gt_i32 s62, 0
  s_cselect_b32 s46, 0, s61
  s_cmp_lg_u32 s46, -1
  s_cbranch_scc1 Lk2_g_rare
Lk2_g_done:
  s_cmp_lg_u32 s67, 5
  s_cbranch_scc1 Lk2_w_rare
Lk2_w_done:
  v_lshlrev_b32 v12, 8, v3
  v_lshl_add_u32 v12, v2, 4, v12
  s_min_u32 s38, s36, 1000
  s_lshl_b32 s38, s38, 12
  s_mov_b32 s16, s74
  s_and_b32 s17, s75, 0xffff
  s_mov_b32 s18, 3200000
  s_mov_b32 s19, 0x20000
  buffer_load_dwordx4 v[208:211], v12, s[16:19], s38 offen
  buffer_load_dwordx4 v[212:215], v12, s[16:19], s38 offen offset:64
  buffer_load_dwordx4 v[216:219], v12, s[16:19], s38 offen offset:128
  buffer_load_dwordx4 v[220:223], v12, s[16:19], s38 offen offset:192
  v_cmp_eq_u32 s[50:51], 3, v2
  v_lshlrev_b32 v9, 3, v3
  v_mov_b32 v11, 0x7fff0000
  s_mov_b32 s40, s56
  s_add_u32 s41, s56, 4096
  s_add_u32 s42, s56, 8192
  s_add_u32 s43, s56, 12288
  s_add_u32 s44, s56, 16384
  v_cndmask_b32 v11, v11, v9, s[50:51]
  v_exp_f32 v156, v156
  v_exp_f32 v157, v157
  v_cvt_pk_bf16_f32 v189, v154, v155
  v_cvt_pk_bf16_f32 v190, v156, v157
  v_mfma_f32_16x16x32_bf16 v[104:107], a[176:179], v[176:179], v[104:107]
  v_cvt_pk_bf16_f32 v16, v16, v17
  v_cvt_pk_bf16_f32 v17, v18, v19
  v_cvt_pk_bf16_f32 v18, v20, v21
  v_exp_f32 v158, v158
  v_mfma_f32_16x16x32_bf16 v[104:107], a[180:183], v[180:183], v[104:107]
  v_cvt_pk_bf16_f32 v19, v22, v23
  buffer_store_dwordx4 v[16:19], v4, s[28:31], s40 offen offset:0 sc1
  v_cvt_pk_bf16_f32 v24, v24, v25
  v_mfma_f32_16x16x32_bf16 v[108:111], a[184:187], v[176:179], v[108:111]
  v_cvt_pk_bf16_f32 v25, v26, v27
  v_cvt_pk_bf16_f32 v26, v28, v29
  v_cvt_pk_bf16_f32 v27, v30, v31
  v_exp_f32 v159, v159
  v_mfma_f32_16x16x32_bf16 v[108:111], a[188:191], v[180:183], v[108:111]
  buffer_store_dwordx4 v[24:27], v4, s[28:31], s40 offen offset:1024 sc1
  v_cvt_pk_bf16_f32 v32, v32, v33
  v_cvt_pk_bf16_f32 v33, v34, v35
  v_cvt_pk_bf16_f32 v191, v158, v159
  v_mfma_f32_16x16x32_bf16 v[112:115], a[128:131], v[184:187], v[112:115]
  v_cvt_pk_bf16_f32 v34, v36, v37
  v_cvt_pk_bf16_f32 v35, v38, v39
  buffer_store_dwordx4 v[32:35], v4, s[28:31], s40 offen offset:2048 sc1
  v_mfma_f32_16x16x32_bf16 v[112:115], a[132:135], v[188:191], v[112:115]
  v_cvt_pk_bf16_f32 v40, v40, v41
  v_cvt_pk_bf16_f32 v41, v42, v43
  v_cvt_pk_bf16_f32 v42, v44, v45
  v_mfma_f32_16x16x32_bf16 v[116:119], a[136:139], v[184:187], v[116:119]
  v_cvt_pk_bf16_f32 v43, v46, v47
  buffer_store_dwordx4 v[40:43], v4, s[28:31], s40 offen offset:3072 sc1
  v_sub_f32 v46, 0, v192
  v_mfma_f32_16x16x32_bf16 v[116:119], a[140:143], v[188:191], v[116:119]
  buffer_store_dwordx2 v[46:47], v11, s[28:31], s44 offen offset:0 sc1
  v_cvt_pk_bf16_f32 v48, v48, v49
  v_cvt_pk_bf16_f32 v49, v50, v51
  v_mfma_f32_16x16x32_bf16 v[120:123], a[144:147], v[184:187], v[120:123]
  v_cvt_pk_bf16_f32 v50, v52, v53
  v_cvt_pk_bf16_f32 v51, v54, v55
  buffer_store_dwordx4 v[48:51], v4, s[28:31], s41 offen offset:0 sc1
  v_mfma_f32_16x16x32_bf16 v[120:123], a[148:151], v[188:191], v[120:123]
  v_cvt_pk_bf16_f32 v56, v56, v57
  v_cvt_pk_bf16_f32 v57, v58, v59
  v_cvt_pk_bf16_f32 v58, v60, v61
  v_mfma_f32_16x16x32_bf16 v[124:127], a[152:155], v[184:187], v[124:127]
  v_cvt_pk_bf16_f32 v59, v62, v63
  buffer_store_dwordx4 v[56:59], v4, s[28:31], s41 offen offset:1024 sc1
  v_cvt_pk_bf16_f32 v64, v64, v65
  v_mfma_f32_16x16x32_bf16 v[124:127], a[156:159], v[188:191], v[124:127]
  v_cvt_pk_bf16_f32 v65, v66, v67
  v_cvt_pk_bf16_f32 v66, v68, v69
  v_cvt_pk_bf16_f32 v67, v70, v71
  v_mfma_f32_16x16x32_bf16 v[128:131], a[160:163], v[184:187], v[128:131]
  buffer_store_dwordx4 v[64:67], v4, s[28:31], s41 offen offset:2048 sc1
  v_cvt_pk_bf16_f32 v72, v72, v73
  v_cvt_pk_bf16_f32 v73, v74, v75
  v_mfma_f32_16x16x32_bf16 v[128:131], a[164:167], v[188:191], v[128:131]
  v_cvt_pk_bf16_f32 v74, v76, v77
  v_cvt_pk_bf16_f32 v75, v78, v79
  buffer_store_dwordx4 v[72:75], v4, s[28:31], s41 offen offset:3072 sc1
  v_mfma_f32_16x16x32_bf16 v[132:135], a[168:171], v[184:187], v[132:135]
  v_sub_f32 v78, 0, v196
  buffer_store_dwordx2 v[78:79], v11, s[28:31], s44 offen offset:128 sc1
  v_cvt_pk_bf16_f32 v80, v80, v81
  v_mfma_f32_16x16x32_bf16 v[132:135], a[172:175], v[188:191], v[132:135]
  v_cvt_pk_bf16_f32 v81, v82, v83
  v_cvt_pk_bf16_f32 v82, v84, v85
  v_cvt_pk_bf16_f32 v83, v86, v87
  v_mfma_f32_16x16x32_bf16 v[136:139], a[176:179], v[184:187], v[136:139]
  buffer_store_dwordx4 v[80:83], v4, s[28:31], s42 offen offset:0 sc1
  v_cvt_pk_bf16_f32 v88, v88, v89
  v_cvt_pk_bf16_f32 v89, v90, v91
  v_mfma_f32_16x16x32_bf16 v[136:139], a[180:183], v[188:191], v[136:139]
  v_cvt_pk_bf16_f32 v90, v92, v93
  v_cvt_pk_bf16_f32 v91, v94, v95
  buffer_store_dwordx4 v[88:91], v4, s[28:31], s42 offen offset:1024 sc1
  v_mfma_f32_16x16x32_bf16 v[140:143], a[184:187], v[184:187], v[140:143]
  v_cvt_pk_bf16_f32 v96, v96, v97
  v_cvt_pk_bf16_f32 v97, v98, v99
  v_cvt_pk_bf16_f32 v98, v100, v101
  v_mfma_f32_16x16x32_bf16 v[140:143], a[188:191], v[188:191], v[140:143]
  v_cvt_pk_bf16_f32 v99, v102, v103
  buffer_store_dwordx4 v[96:99], v4, s[28:31], s42 offen offset:2048 sc1
  v_cvt_pk_bf16_f32 v104, v104, v105
  v_cvt_pk_bf16_f32 v105, v106, v107
  v_cvt_pk_bf16_f32 v106, v108, v109
  v_cvt_pk_bf16_f32 v107, v110, v111
  buffer_store_dwordx4 v[104:107], v4, s[28:31], s42 offen offset:3072 sc1
  v_sub_f32 v110, 0, v200
  buffer_store_dwordx2 v[110:111], v11, s[28:31], s44 offen offset:256 sc1
  v_cvt_pk_bf16_f32 v112, v112, v113
  v_cvt_pk_bf16_f32 v113, v114, v115
  v_cvt_pk_bf16_f32 v114, v116, v117
  v_cvt_pk_bf16_f32 v115, v118, v119
  buffer_store_dwordx4 v[112:115], v4, s[28:31], s43 offen offset:0 sc1
  v_cvt_pk_bf16_f32 v120, v120, v121
  v_cvt_pk_bf16_f32 v121, v122, v123
  v_cvt_pk_bf16_f32 v122, v124, v125
  v_cvt_pk_bf16_f32 v123, v126, v127
  buffer_store_dwordx4 v[120:123], v4, s[28:31], s43 offen offset:1024 sc1
  v_cvt_pk_bf16_f32 v128, v128, v129
  v_cvt_pk_bf16_f32 v129, v130, v131
  v_cvt_pk_bf16_f32 v130, v132, v133
  v_cvt_pk_bf16_f32 v131, v134, v135
  buffer_store_dwordx4 v[128:131], v4, s[28:31], s43 offen offset:2048 sc1
  v_cvt_pk_bf16_f32 v136, v136, v137
  v_cvt_pk_bf16_f32 v137, v138, v139
  v_cvt_pk_bf16_f32 v138, v140, v141
  v_cvt_pk_bf16_f32 v139, v142, v143
  buffer_store_dwordx4 v[136:139], v4, s[28:31], s43 offen offset:3072 sc1
  v_sub_f32 v142, 0, v204
  buffer_store_dwordx2 v[142:143], v11, s[28:31], s44 offen offset:384 sc1
  s_mov_b32 s48, 0x71800000
  v_add_f32 v14, v47, v79
  v_add_f32 v7, v111, v143
  v_add_f32 v7, v14, v7
  v_cmp_nlt_f32 vcc, v7, s48
  s_lshl_b32 s47, s33, 2
  s_add_u32 s47, s47, 153600
  s_and_b64 s[52:53], vcc, s[50:51]
  s_cselect_b32 s46, 1, 0
  v_mov_b32 v14, s47
  v_mov_b32 v7, s46
  ds_write_b32 v14, v7
  v_mov_b32 v14, 153600
  s_lshl_b32 s47, s33, 7
  s_lshl_b32 s48, s34, 2
  s_add_u32 s47, s47, s48
  s_add_u32 s79, s47, s78
  s_waitcnt lgkmcnt(0)
  s_barrier
  ds_read_b128 v[144:147], v14
  v_lshlrev_b32 v10, 26, v1
  s_waitcnt lgkmcnt(0)
  v_or_b32 v144, v144, v145
  v_or3_b32 v144, v144, v146, v147
  s_nop 0
  v_readfirstlane_b32 s47, v144
  s_nop 0
  s_andn2_b32 s47, s47, s45
  s_cmp_lg_u32 s47, 0
  s_cbranch_scc1 Lk2_redo
  v_mov_b32 v13, v10
  v_mov_b32 v15, 1
  s_waitcnt vmcnt(15)
  buffer_store_dword v15, v13, s[28:31], s79 offen offset:0 sc1
  s_cmp_ge_u32 s36, 782
  s_cbranch_scc1 Lk2_nofinal
  v_add_u32 v10, 65536, v4
  v_lshlrev_b32 v7, 16, v241
  v_mul_f32 v7, 0.5, v7
  v_add_u32 v5, 154688, v5
  v_add_u32 v6, 154688, v6
  v_add_u32 v14, s49, v4
  s_mov_b32 s48, 0xffff0000
  s_lshr_b32 s46, s36, 2
  s_mul_i32 s46, s46, 17408
  s_add_u32 s46, s46, 16777216
  s_and_b32 s47, s36, 3
  s_lshl_b32 s59, s47, 12
  s_add_u32 s59, s59, s46
  s_lshl_b32 s60, s47, 7
  s_add_u32 s60, s60, s46
  s_add_u32 s60, s60, 16384
  ds_read_b128 a[128:131], v14 offset:0
  ds_read_b128 a[132:135], v14 offset:1024
  ds_read_b128 a[136:139], v14 offset:2048
  ds_read_b128 a[140:143], v14 offset:3072
  v_accvgpr_read_b32 v168, a192
  v_accvgpr_read_b32 v169, a193
  v_mul_f32 v168, v168, v7
  v_mul_f32 v169, v169, v7
  v_cvt_pk_bf16_f32 v176, v168, v169
  v_accvgpr_read_b32 v170, a194
  v_accvgpr_read_b32 v171, a195
  v_mul_f32 v170, v170, v7
  v_mul_f32 v171, v171, v7
  v_cvt_pk_bf16_f32 v177, v170, v171
  v_accvgpr_read_b32 v172, a196
  v_accvgpr_read_b32 v173, a197
  v_mul_f32 v172, v172, v7
  v_mul_f32 v173, v173, v7
  v_cvt_pk_bf16_f32 v178, v172, v173
  v_accvgpr_read_b32 v174, a198
  v_accvgpr_read_b32 v175, a199
  v_mul_f32 v174, v174, v7
  v_mul_f32 v175, v175, v7
  v_cvt_pk_bf16_f32 v179, v174, v175
  v_accvgpr_read_b32 v168, a200
  v_accvgpr_read_b32 v169, a201
  v_mul_f32 v168, v168, v7
  v_mul_f32 v169, v169, v7
  v_cvt_pk_bf16_f32 v180, v168, v169
  v_accvgpr_read_b32 v170, a202
  v_accvgpr_read_b32 v171, a203
  v_mul_f32 v170, v170, v7
  v_mul_f32 v171, v171, v7
  v_cvt_pk_bf16_f32 v181, v170, v171
  v_accvgpr_read_b32 v172, a204
  v_accvgpr_read_b32 v173, a205
  v_mul_f32 v172, v172, v7
  v_mul_f32 v173, v173, v7
  v_cvt_pk_bf16_f32 v182, v172, v173
  v_accvgpr_read_b32 v174, a206
  v_accvgpr_read_b32 v175, a207
  v_mul_f32 v174, v174, v7
  v_mul_f32 v175, v175, v7
  v_cvt_pk_bf16_f32 v183, v174, v175
  v_accvgpr_read_b32 v168, a208
  v_accvgpr_read_b32 v169, a209
  v_mul_f32 v168, v168, v7
  v_mul_f32 v169, v169, v7
  v_cvt_pk_bf16_f32 v184, v168, v169
  v_accvgpr_read_b32 v170, a210
  v_accvgpr_read_b32 v171, a211
  v_mul_f32 v170, v170, v7
  v_mul_f32 v171, v171, v7
  v_cvt_pk_bf16_f32 v185, v170, v171
  v_accvgpr_read_b32 v172, a212
  v_accvgpr_read_b32 v173, a213
  v_mul_f32 v172, v172, v7
  v_mul_f32 v173, v173, v7
  v_cvt_pk_bf16_f32 v186, v172, v173
  v_accvgpr_read_b32 v174, a214
  v_accvgpr_read_b32 v175, a215
  v_mul_f32 v174, v174, v7
  v_mul_f32 v175, v175, v7
  v_cvt_pk_bf16_f32 v187, v174, v175
  v_accvgpr_read_b32 v168, a216
  v_accvgpr_read_b32 v169, a217
  v_mul_f32 v168, v168, v7
  v_mul_f32 v169, v169, v7
  v_cvt_pk_bf16_f32 v188, v168, v169
  v_accvgpr_read_b32 v170, a218
  v_accvgpr_read_b32 v171, a219
  v_mul_f32 v170, v170, v7
  v_mul_f32 v171, v171, v7
  v_cvt_pk_bf16_f32 v189, v170, v171
  v_accvgpr_read_b32 v172, a220
  v_accvgpr_read_b32 v173, a221
  v_mul_f32 v172, v172, v7
  v_mul_f32 v173, v173, v7
  v_cvt_pk_bf16_f32 v190, v172, v173
  v_accvgpr_read_b32 v174, a222
  v_accvgpr_read_b32 v175, a223
  v_mul_f32 v174, v174, v7
  v_mul_f32 v175, v175, v7
  v_cvt_pk_bf16_f32 v191, v174, v175
  s_waitcnt vmcnt(11)
  buffer_store_dword v15, v13, s[28:31], s79 offen offset:32 sc1
  ds_read_b128 a[144:147], v5 offset:0
  ds_read_b128 a[148:151], v5 offset:1024
  ds_read_b128 a[152:155], v5 offset:2048
  ds_read_b128 a[156:159], v5 offset:3072
  ds_read_b128 a[160:163], v5 offset:4096
  ds_read_b128 a[164:167], v5 offset:5120
  ds_read_b128 a[168:171], v5 offset:6144
  ds_read_b128 a[172:175], v5 offset:7168
  ds_read_b64_tr_b16 a[224:225], v6 offset:0
  ds_read_b64_tr_b16 a[226:227], v6 offset:4096
  ds_read_b64_tr_b16 a[228:229], v6 offset:512
  ds_read_b64_tr_b16 a[230:231], v6 offset:4608
  ds_read_b64_tr_b16 a[232:233], v6 offset:1024
  ds_read_b64_tr_b16 a[234:235], v6 offset:5120
  ds_read_b64_tr_b16 a[236:237], v6 offset:1536
  ds_read_b64_tr_b16 a[238:239], v6 offset:5632
  ds_read_b64_tr_b16 a[240:241], v6 offset:2048
  ds_read_b64_tr_b16 a[242:243], v6 offset:6144
  ds_read_b64_tr_b16 a[244:245], v6 offset:2560
  ds_read_b64_tr_b16 a[246:247], v6 offset:6656
  ds_read_b64_tr_b16 a[248:249], v6 offset:3072
  ds_read_b64_tr_b16 a[250:251], v6 offset:7168
  ds_read_b64_tr_b16 a[252:253], v6 offset:3584
  ds_read_b64_tr_b16 a[254:255], v6 offset:7680
  s_waitcnt lgkmcnt(15)
  v_mfma_f32_16x16x32_bf16 v[192:195], a[144:147], a[128:131], 0
  v_mfma_f32_16x16x32_bf16 v[192:195], a[148:151], a[132:135], v[192:195]
  v_mfma_f32_16x16x32_bf16 v[192:195], a[152:155], a[136:139], v[192:195]
  v_mfma_f32_16x16x32_bf16 v[192:195], a[156:159], a[140:143], v[192:195]
  v_mfma_f32_16x16x32_bf16 v[196:199], a[160:163], a[128:131], 0
  v_mfma_f32_16x16x32_bf16 v[196:199], a[164:167], a[132:135], v[196:199]
  v_mfma_f32_16x16x32_bf16 v[196:199], a[168:171], a[136:139], v[196:199]
  v_mfma_f32_16x16x32_bf16 v[196:199], a[172:175], a[140:143], v[196:199]
  v_lshlrev_b32 v224, 16, v208
  v_and_b32 v225, s48, v208
  v_lshlrev_b32 v226, 16, v209
  v_and_b32 v227, s48, v209
  v_lshlrev_b32 v228, 16, v210
  v_and_b32 v229, s48, v210
  v_lshlrev_b32 v230, 16, v211
  v_and_b32 v231, s48, v211
  v_lshlrev_b32 v232, 16, v212
  v_and_b32 v233, s48, v212
  v_lshlrev_b32 v234, 16, v213
  v_and_b32 v235, s48, v213
  v_lshlrev_b32 v236, 16, v214
  v_and_b32 v237, s48, v214
  v_lshlrev_b32 v238, 16, v215
  v_and_b32 v239, s48, v215
  v_lshlrev_b32 v240, 16, v216
  v_and_b32 v241, s48, v216
  v_lshlrev_b32 v242, 16, v217
  v_and_b32 v243, s48, v217
  v_lshlrev_b32 v244, 16, v218
  v_and_b32 v245, s48, v218
  v_lshlrev_b32 v246, 16, v219
  v_and_b32 v247, s48, v219
  v_lshlrev_b32 v248, 16, v220
  v_and_b32 v249, s48, v220
  v_lshlrev_b32 v250, 16, v221
  v_and_b32 v251, s48, v221
  v_lshlrev_b32 v252, 16, v222
  v_and_b32 v253, s48, v222
  v_lshlrev_b32 v254, 16, v223
  v_and_b32 v255, s48, v223
  s_waitcnt vmcnt(7)
  buffer_store_dword v15, v13, s[28:31], s79 offen offset:64 sc1
  v_cmp_eq_u32 vcc, 0, v2
  v_mov_b32 v7, 0xff800000
  s_nop 0
  v_cndmask_b32 v196, v7, v196, vcc
  v_cndmask_b32 v197, v7, v197, vcc
  v_cndmask_b32 v198, v7, v198, vcc
  v_cndmask_b32 v199, v7, v199, vcc
  v_max3_f32 v202, v192, v193, v194
  v_max3_f32 v202, v202, v195, v196
  v_max3_f32 v202, v202, v197, v198
  v_max_f32 v202, v202, v199
  v_mov_b32 v7, v202
  s_nop 1
  v_permlane16_swap_b32 v202, v7
  v_max_f32 v202, v202, v7
  v_mov_b32 v7, v202
  s_nop 1
  v_permlane32_swap_b32 v202, v7
  v_max_f32 v202, v202, v7
  v_sub_f32 v192, v192, v202
  v_sub_f32 v193, v193, v202
  v_sub_f32 v194, v194, v202
  v_sub_f32 v195, v195, v202
  v_sub_f32 v196, v196, v202
  v_sub_f32 v197, v197, v202
  v_sub_f32 v198, v198, v202
  v_sub_f32 v199, v199, v202
  v_exp_f32 v192, v192
  v_exp_f32 v193, v193
  v_exp_f32 v194, v194
  v_exp_f32 v195, v195
  v_exp_f32 v196, v196
  v_exp_f32 v197, v197
  v_exp_f32 v198, v198
  v_exp_f32 v199, v199
  v_cvt_pk_bf16_f32 v128, v192, v193
  v_cvt_pk_bf16_f32 v129, v194, v195
  v_cvt_pk_bf16_f32 v130, v196, v197
  v_cvt_pk_bf16_f32 v131, v198, v199
  s_waitcnt lgkmcnt(14)
  s_nop 0
  v_mfma_f32_16x16x32_bf16 v[96:99], a[224:227], v[128:131], 0
  s_waitcnt lgkmcnt(12)
  v_mfma_f32_16x16x32_bf16 v[100:103], a[228:231], v[128:131], 0
  s_waitcnt lgkmcnt(10)
  v_mfma_f32_16x16x32_bf16 v[104:107], a[232:235], v[128:131], 0
  s_waitcnt lgkmcnt(8)
  v_mfma_f32_16x16x32_bf16 v[108:111], a[236:239], v[128:131], 0
  s_waitcnt lgkmcnt(6)
  v_mfma_f32_16x16x32_bf16 v[112:115], a[240:243], v[128:131], 0
  s_waitcnt lgkmcnt(4)
  v_mfma_f32_16x16x32_bf16 v[116:119], a[244:247], v[128:131], 0
  s_waitcnt lgkmcnt(2)
  v_mfma_f32_16x16x32_bf16 v[120:123], a[248:251], v[128:131], 0
  s_waitcnt lgkmcnt(0)
  v_mfma_f32_16x16x32_bf16 v[124:127], a[252:255], v[128:131], 0
  s_waitcnt vmcnt(3)
  buffer_store_dword v15, v13, s[28:31], s79 offen offset:96 sc1
  ds_read_b128 a[0:3], v10 offset:32768
  ds_read_b128 a[4:7], v10 offset:33792
  ds_read_b128 a[8:11], v10 offset:34816
  ds_read_b128 a[12:15], v10 offset:35840
  ds_read_b128 a[16:19], v10 offset:36864
  ds_read_b128 a[20:23], v10 offset:37888
  ds_read_b128 a[24:27], v10 offset:38912
  ds_read_b128 a[28:31], v10 offset:39936
  ds_read_b128 a[32:35], v10 offset:40960
  ds_read_b128 a[36:39], v10 offset:41984
  ds_read_b128 a[40:43], v10 offset:43008
  ds_read_b128 a[44:47], v10 offset:44032
  ds_read_b128 a[48:51], v10 offset:45056
  ds_read_b128 a[52:55], v10 offset:46080
  ds_read_b128 a[56:59], v10 offset:47104
  ds_read_b128 a[60:63], v10 offset:48128
  ds_read_b128 a[64:67], v10 offset:49152
  ds_read_b128 a[68:71], v10 offset:50176
  ds_read_b128 a[72:75], v10 offset:51200
  ds_read_b128 a[76:79], v10 offset:52224
  ds_read_b128 a[80:83], v10 offset:53248
  ds_read_b128 a[84:87], v10 offset:54272
  ds_read_b128 a[88:91], v10 offset:55296
  ds_read_b128 a[92:95], v10 offset:56320
  ds_read_b128 a[96:99], v10 offset:57344
  ds_read_b128 a[100:103], v10 offset:58368
  ds_read_b128 a[104:107], v10 offset:59392
  ds_read_b128 a[108:111], v10 offset:60416
  ds_read_b128 a[112:115], v10 offset:61440
  ds_read_b128 a[116:119], v10 offset:62464
  ds_read_b128 a[120:123], v10 offset:63488
  ds_read_b128 a[124:127], v10 offset:64512
  ds_read_b128 v[144:147], v10 offset:0
  ds_read_b128 v[148:151], v10 offset:1024
  ds_read_b128 v[152:155], v10 offset:2048
  ds_read_b128 v[156:159], v10 offset:3072
  v_mov_b32 v7, v127
  v_mov_b32 v203, v127
  s_nop 1
  v_permlane32_swap_b32 v7, v203
  v_mov_b32 v7, v203
  s_nop 1
  v_permlane16_swap_b32 v7, v203
  v_min_u32 v14, 4, v1
  v_lshlrev_b32 v14, 2, v14
  s_and_b32 s46, s36, 15
  s_lshl_b32 s46, s46, 5
  s_add_u32 s46, s46, s78
  s_mov_b32 s47, 0
  buffer_load_dword v11, v14, s[28:31], s46 offen sc1
  ds_read_b128 v[160:163], v10 offset:4096
  ds_read_b128 v[164:167], v10 offset:5120
  ds_read_b128 v[168:171], v10 offset:6144
  ds_read_b128 v[172:175], v10 offset:7168
  s_waitcnt lgkmcnt(7)
  v_mfma_f32_16x16x32_bf16 v[224:227], v[144:147], v[176:179], v[224:227]
  s_waitcnt lgkmcnt(6)
  v_mfma_f32_16x16x32_bf16 v[224:227], v[148:151], v[180:183], v[224:227]
  s_waitcnt lgkmcnt(5)
  v_mfma_f32_16x16x32_bf16 v[224:227], v[152:155], v[184:187], v[224:227]
  s_waitcnt lgkmcnt(4)
  v_mfma_f32_16x16x32_bf16 v[224:227], v[156:159], v[188:191], v[224:227]
  ds_read_b128 v[144:147], v10 offset:8192
  ds_read_b128 v[148:151], v10 offset:9216
  ds_read_b128 v[152:155], v10 offset:10240
  ds_read_b128 v[156:159], v10 offset:11264
  s_waitcnt lgkmcnt(7)
  v_mfma_f32_16x16x32_bf16 v[228:231], v[160:163], v[176:179], v[228:231]
  s_waitcnt lgkmcnt(6)
  v_mfma_f32_16x16x32_bf16 v[228:231], v[164:167], v[180:183], v[228:231]
  s_waitcnt lgkmcnt(5)
  v_mfma_f32_16x16x32_bf16 v[228:231], v[168:171], v[184:187], v[228:231]
  s_waitcnt lgkmcnt(4)
  v_mfma_f32_16x16x32_bf16 v[228:231], v[172:175], v[188:191], v[228:231]
  ds_read_b128 v[160:163], v10 offset:12288
  ds_read_b128 v[164:167], v10 offset:13312
  ds_read_b128 v[168:171], v10 offset:14336
  ds_read_b128 v[172:175], v10 offset:15360
  s_waitcnt lgkmcnt(7)
  v_mfma_f32_16x16x32_bf16 v[232:235], v[144:147], v[176:179], v[232:235]
  s_waitcnt lgkmcnt(6)
  v_mfma_f32_16x16x32_bf16 v[232:235], v[148:151], v[180:183], v[232:235]
  s_waitcnt lgkmcnt(5)
  v_mfma_f32_16x16x32_bf16 v[232:235], v[152:155], v[184:187], v[232:235]
  s_waitcnt lgkmcnt(4)
  v_mfma_f32_16x16x32_bf16 v[232:235], v[156:159], v[188:191], v[232:235]
  ds_read_b128 v[144:147], v10 offset:16384
  ds_read_b128 v[148:151], v10 offset:17408
  ds_read_b128 v[152:155], v10 offset:18432
  ds_read_b128 v[156:159], v10 offset:19456
  s_waitcnt lgkmcnt(7)
  v_mfma_f32_16x16x32_bf16 v[236:239], v[160:163], v[176:179], v[236:239]
  s_waitcnt lgkmcnt(6)
  v_mfma_f32_16x16x32_bf16 v[236:239], v[164:167], v[180:183], v[236:239]
  s_waitcnt lgkmcnt(5)
  v_mfma_f32_16x16x32_bf16 v[236:239], v[168:171], v[184:187], v[236:239]
  s_waitcnt lgkmcnt(4)
  v_mfma_f32_16x16x32_bf16 v[236:239], v[172:175], v[188:191], v[236:239]
  ds_read_b128 v[160:163], v10 offset:20480
  ds_read_b128 v[164:167], v10 offset:21504
  ds_read_b128 v[168:171], v10 offset:22528
  ds_read_b128 v[172:175], v10 offset:23552
  s_waitcnt lgkmcnt(7)
  v_mfma_f32_16x16x32_bf16 v[240:243], v[144:147], v[176:179], v[240:243]
  s_waitcnt lgkmcnt(6)
  v_mfma_f32_16x16x32_bf16 v[240:243], v[148:151], v[180:183], v[240:243]
  s_waitcnt lgkmcnt(5)
  v_mfma_f32_16x16x32_bf16 v[240:243], v[152:155], v[184:187], v[240:243]
  s_waitcnt lgkmcnt(4)
  v_mfma_f32_16x16x32_bf16 v[240:243], v[156:159], v[188:191], v[240:243]
  ds_read_b128 v[144:147], v10 offset:24576
  ds_read_b128 v[148:151], v10 offset:25600
  ds_read_b128 v[152:155], v10 offset:26624
  ds_read_b128 v[156:159], v10 offset:27648
  s_waitcnt lgkmcnt(7)
  v_mfma_f32_16x16x32_bf16 v[244:247], v[160:163], v[176:179], v[244:247]
  s_waitcnt lgkmcnt(6)
  v_mfma_f32_16x16x32_bf16 v[244:247], v[164:167], v[180:183], v[244:247]
  s_waitcnt lgkmcnt(5)
  v_mfma_f32_16x16x32_bf16 v[244:247], v[168:171], v[184:187], v[244:247]
  s_waitcnt lgkmcnt(4)
  v_mfma_f32_16x16x32_bf16 v[244:247], v[172:175], v[188:191], v[244:247]
  ds_read_b128 v[160:163], v10 offset:28672
  ds_read_b128 v[164:167], v10 offset:29696
  ds_read_b128 v[168:171], v10 offset:30720
  ds_read_b128 v[172:175], v10 offset:31744
  s_waitcnt lgkmcnt(7)
  v_mfma_f32_16x16x32_bf16 v[248:251], v[144:147], v[176:179], v[248:251]
  s_waitcnt lgkmcnt(6)
  v_mfma_f32_16x16x32_bf16 v[248:251], v[148:151], v[180:183], v[248:251]
  s_waitcnt lgkmcnt(5)
  v_mfma_f32_16x16x32_bf16 v[248:251], v[152:155], v[184:187], v[248:251]
  s_waitcnt lgkmcnt(4)
  v_mfma_f32_16x16x32_bf16 v[248:251], v[156:159], v[188:191], v[248:251]
  s_waitcnt lgkmcnt(3)
  v_mfma_f32_16x16x32_bf16 v[252:255], v[160:163], v[176:179], v[252:255]
  s_waitcnt lgkmcnt(2)
  v_mfma_f32_16x16x32_bf16 v[252:255], v[164:167], v[180:183], v[252:255]
  s_waitcnt lgkmcnt(1)
  v_mfma_f32_16x16x32_bf16 v[252:255], v[168:171], v[184:187], v[252:255]
  s_waitcnt lgkmcnt(0)
  v_mfma_f32_16x16x32_bf16 v[252:255], v[172:175], v[188:191], v[252:255]
  s_mov_b32 s20, s76
  s_and_b32 s21, s77, 0xffff
  s_mov_b32 s22, 3200000
  s_mov_b32 s23, 0x20000
  s_add_u32 s41, s59, 4194304
  s_add_u32 s42, s59, 8388608
  s_add_u32 s43, s59, 12582912
  s_add_u32 s44, s59, 16777216
  s_branch Lk2_poll1
Lk2_poll:
  s_waitcnt vmcnt(0)
  buffer_load_dword v11, v14, s[28:31], s46 offen sc1
  s_add_u32 s47, s47, 1
Lk2_poll1:
  s_waitcnt vmcnt(0)
  v_cmp_ne_u32 vcc, 1, v11
  s_cmp_gt_u32 s47, 1048576
  s_cbranch_scc1 Lk2_fetch
  s_cbranch_vccnz Lk2_poll
Lk2_fetch:
  s_mov_b32 s46, s60
  buffer_load_dwordx2 v[192:193], v9, s[28:31], s46 offen sc1
  s_add_u32 s46, s46, 4194304
  buffer_load_dwordx2 v[194:195], v9, s[28:31], s46 offen sc1
  s_add_u32 s46, s46, 4194304
  buffer_load_dwordx2 v[196:197], v9, s[28:31], s46 offen sc1
  s_add_u32 s46, s46, 4194304
  buffer_load_dwordx2 v[198:199], v9, s[28:31], s46 offen sc1
  s_add_u32 s46, s46, 4194304
  buffer_load_dwordx2 v[200:201], v9, s[28:31], s46 offen sc1
  buffer_load_dwordx4 v[16:19], v4, s[28:31], s59 offen offset:0 sc1
  buffer_load_dwordx4 v[32:35], v4, s[28:31], s41 offen offset:0 sc1
  buffer_load_dwordx4 v[48:51], v4, s[28:31], s42 offen offset:0 sc1
  buffer_load_dwordx4 v[64:67], v4, s[28:31], s43 offen offset:0 sc1
  buffer_load_dwordx4 v[80:83], v4, s[28:31], s44 offen offset:0 sc1
  buffer_load_dwordx4 v[20:23], v4, s[28:31], s59 offen offset:1024 sc1
  buffer_load_dwordx4 v[36:39], v4, s[28:31], s41 offen offset:1024 sc1
  buffer_load_dwordx4 v[52:55], v4, s[28:31], s42 offen offset:1024 sc1
  buffer_load_dwordx4 v[68:71], v4, s[28:31], s43 offen offset:1024 sc1
  buffer_load_dwordx4 v[84:87], v4, s[28:31], s44 offen offset:1024 sc1
  buffer_load_dwordx4 v[24:27], v4, s[28:31], s59 offen offset:2048 sc1
  buffer_load_dwordx4 v[40:43], v4, s[28:31], s41 offen offset:2048 sc1
  buffer_load_dwordx4 v[56:59], v4, s[28:31], s42 offen offset:2048 sc1
  buffer_load_dwordx4 v[72:75], v4, s[28:31], s43 offen offset:2048 sc1
  buffer_load_dwordx4 v[88:91], v4, s[28:31], s44 offen offset:2048 sc1
  buffer_load_dwordx4 v[28:31], v4, s[28:31], s59 offen offset:3072 sc1
  buffer_load_dwordx4 v[44:47], v4, s[28:31], s41 offen offset:3072 sc1
  buffer_load_dwordx4 v[60:63], v4, s[28:31], s42 offen offset:3072 sc1
  buffer_load_dwordx4 v[76:79], v4, s[28:31], s43 offen offset:3072 sc1
  buffer_load_dwordx4 v[92:95], v4, s[28:31], s44 offen offset:3072 sc1
  s_waitcnt vmcnt(24)
  v_max_f32 v193, 0x03800000, v193
  s_waitcnt vmcnt(23)
  v_max_f32 v195, 0x03800000, v195
  s_waitcnt vmcnt(22)
  v_max_f32 v197, 0x03800000, v197
  s_waitcnt vmcnt(21)
  v_max_f32 v199, 0x03800000, v199
  s_waitcnt vmcnt(20)
  v_max_f32 v201, 0x03800000, v201
  v_log_f32 v156, v193
  v_log_f32 v157, v195
  v_log_f32 v158, v197
  v_log_f32 v159, v199
  v_log_f32 v160, v201
  v_log_f32 v161, v203
  v_add_f32 v156, v156, v192
  v_add_f32 v157, v157, v194
  v_add_f32 v158, v158, v196
  v_add_f32 v159, v159, v198
  v_add_f32 v160, v160, v200
  v_add_f32 v161, v161, v202
  v_max3_f32 v11, v156, v157, v158
  v_max3_f32 v11, v11, v159, v160
  v_max_f32 v11, v11, v161
  v_sub_f32 v156, v156, v11
  v_sub_f32 v157, v157, v11
  v_sub_f32 v158, v158, v11
  v_sub_f32 v159, v159, v11
  v_sub_f32 v160, v160, v11
  v_sub_f32 v161, v161, v11
  v_exp_f32 v156, v156
  v_exp_f32 v157, v157
  v_exp_f32 v158, v158
  v_exp_f32 v159, v159
  v_exp_f32 v160, v160
  v_exp_f32 v161, v161
  v_rcp_f32 v192, v193
  v_rcp_f32 v194, v195
  v_rcp_f32 v196, v197
  v_rcp_f32 v198, v199
  v_rcp_f32 v200, v201
  v_rcp_f32 v202, v203
  v_add_f32 v11, v156, v157
  v_add_f32 v7, v158, v159
  v_add_f32 v11, v11, v160
  v_add_f32 v7, v7, v161
  v_add_f32 v11, v11, v7
  v_rcp_f32 v11, v11
  s_nop 0
  v_mul_f32 v156, v156, v11
  v_mul_f32 v157, v157, v11
  v_mul_f32 v158, v158, v11
  v_mul_f32 v159, v159, v11
  v_mul_f32 v160, v160, v11
  v_mul_f32 v161, v161, v11
  v_mul_f32 v144, v156, v192
  v_mul_f32 v146, v157, v194
  v_mul_f32 v148, v158, v196
  v_mul_f32 v150, v159, v198
  v_mul_f32 v152, v160, v200
  v_mul_f32 v154, v161, v202
  v_pk_mul_f32 v[96:97], v[96:97], v[154:155] op_sel_hi:[1,0]
  v_pk_mul_f32 v[98:99], v[98:99], v[154:155] op_sel_hi:[1,0]
  v_pk_mul_f32 v[100:101], v[100:101], v[154:155] op_sel_hi:[1,0]
  v_pk_mul_f32 v[102:103], v[102:103], v[154:155] op_sel_hi:[1,0]
  v_pk_mul_f32 v[104:105], v[104:105], v[154:155] op_sel_hi:[1,0]
  v_pk_mul_f32 v[106:107], v[106:107], v[154:155] op_sel_hi:[1,0]
  v_pk_mul_f32 v[108:109], v[108:109], v[154:155] op_sel_hi:[1,0]
  v_pk_mul_f32 v[110:111], v[110:111], v[154:155] op_sel_hi:[1,0]
  v_pk_mul_f32 v[112:113], v[112:113], v[154:155] op_sel_hi:[1,0]
  v_pk_mul_f32 v[114:115], v[114:115], v[154:155] op_sel_hi:[1,0]
  v_pk_mul_f32 v[116:117], v[116:117], v[154:155] op_sel_hi:[1,0]
  v_pk_mul_f32 v[118:119], v[118:119], v[154:155] op_sel_hi:[1,0]
  v_pk_mul_f32 v[120:121], v[120:121], v[154:155] op_sel_hi:[1,0]
  v_pk_mul_f32 v[122:123], v[122:123], v[154:155] op_sel_hi:[1,0]
  v_pk_mul_f32 v[124:125], v[124:125], v[154:155] op_sel_hi:[1,0]
  v_pk_mul_f32 v[126:127], v[126:127], v[154:155] op_sel_hi:[1,0]
  s_waitcnt vmcnt(19)
  v_lshlrev_b32 v192, 16, v16
  v_and_b32 v193, s48, v16
  v_pk_fma_f32 v[96:97], v[192:193], v[144:145], v[96:97] op_sel_hi:[1,0,1]
  v_lshlrev_b32 v194, 16, v17
  v_and_b32 v195, s48, v17
  v_pk_fma_f32 v[98:99], v[194:195], v[144:145], v[98:99] op_sel_hi:[1,0,1]
  v_lshlrev_b32 v196, 16, v18
  v_and_b32 v197, s48, v18
  v_pk_fma_f32 v[100:101], v[196:197], v[144:145], v[100:101] op_sel_hi:[1,0,1]
  v_lshlrev_b32 v198, 16, v19
  v_and_b32 v199, s48, v19
  v_pk_fma_f32 v[102:103], v[198:199], v[144:145], v[102:103] op_sel_hi:[1,0,1]
  s_waitcnt vmcnt(18)
  v_lshlrev_b32 v192, 16, v32
  v_and_b32 v193, s48, v32
  v_pk_fma_f32 v[96:97], v[192:193], v[146:147], v[96:97] op_sel_hi:[1,0,1]
  v_lshlrev_b32 v194, 16, v33
  v_and_b32 v195, s48, v33
  v_pk_fma_f32 v[98:99], v[194:195], v[146:147], v[98:99] op_sel_hi:[1,0,1]
  v_lshlrev_b32 v196, 16, v34
  v_and_b32 v197, s48, v34
  v_pk_fma_f32 v[100:101], v[196:197], v[146:147], v[100:101] op_sel_hi:[1,0,1]
  v_lshlrev_b32 v198, 16, v35
  v_and_b32 v199, s48, v35
  v_pk_fma_f32 v[102:103], v[198:199], v[146:147], v[102:103] op_sel_hi:[1,0,1]
  s_waitcnt vmcnt(17)
  v_lshlrev_b32 v192, 16, v48
  v_and_b32 v193, s48, v48
  v_pk_fma_f32 v[96:97], v[192:193], v[148:149], v[96:97] op_sel_hi:[1,0,1]
  v_lshlrev_b32 v194, 16, v49
  v_and_b32 v195, s48, v49
  v_pk_fma_f32 v[98:99], v[194:195], v[148:149], v[98:99] op_sel_hi:[1,0,1]
  v_lshlrev_b32 v196, 16, v50
  v_and_b32 v197, s48, v50
  v_pk_fma_f32 v[100:101], v[196:197], v[148:149], v[100:101] op_sel_hi:[1,0,1]
  v_lshlrev_b32 v198, 16, v51
  v_and_b32 v199, s48, v51
  v_pk_fma_f32 v[102:103], v[198:199], v[148:149], v[102:103] op_sel_hi:[1,0,1]
  s_waitcnt vmcnt(16)
  v_lshlrev_b32 v192, 16, v64
  v_and_b32 v193, s48, v64
  v_pk_fma_f32 v[96:97], v[192:193], v[150:151], v[96:97] op_sel_hi:[1,0,1]
  v_lshlrev_b32 v194, 16, v65
  v_and_b32 v195, s48, v65
  v_pk_fma_f32 v[98:99], v[194:195], v[150:151], v[98:99] op_sel_hi:[1,0,1]
  v_lshlrev_b32 v196, 16, v66
  v_and_b32 v197, s48, v66
  v_pk_fma_f32 v[100:101], v[196:197], v[150:151], v[100:101] op_sel_hi:[1,0,1]
  v_lshlrev_b32 v198, 16, v67
  v_and_b32 v199, s48, v67
  v_pk_fma_f32 v[102:103], v[198:199], v[150:151], v[102:103] op_sel_hi:[1,0,1]
  s_waitcnt vmcnt(15)
  v_lshlrev_b32 v192, 16, v80
  v_and_b32 v193, s48, v80
  v_pk_fma_f32 v[96:97], v[192:193], v[152:153], v[96:97] op_sel_hi:[1,0,1]
  v_lshlrev_b32 v194, 16, v81
  v_and_b32 v195, s48, v81
  v_pk_fma_f32 v[98:99], v[194:195], v[152:153], v[98:99] op_sel_hi:[1,0,1]
  v_lshlrev_b32 v196, 16, v82
  v_and_b32 v197, s48, v82
  v_pk_fma_f32 v[100:101], v[196:197], v[152:153], v[100:101] op_sel_hi:[1,0,1]
  v_lshlrev_b32 v198, 16, v83
  v_and_b32 v199, s48, v83
  v_pk_fma_f32 v[102:103], v[198:199], v[152:153], v[102:103] op_sel_hi:[1,0,1]
  v_cvt_pk_bf16_f32 v128, v96, v97
  v_cvt_pk_bf16_f32 v129, v98, v99
  v_cvt_pk_bf16_f32 v130, v100, v101
  v_cvt_pk_bf16_f32 v131, v102, v103
  s_waitcnt vmcnt(14)
  v_lshlrev_b32 v192, 16, v20
  v_and_b32 v193, s48, v20
  v_pk_fma_f32 v[104:105], v[192:193], v[144:145], v[104:105] op_sel_hi:[1,0,1]
  v_lshlrev_b32 v194, 16, v21
  v_and_b32 v195, s48, v21
  v_pk_fma_f32 v[106:107], v[194:195], v[144:145], v[106:107] op_sel_hi:[1,0,1]
  v_mfma_f32_16x16x32_bf16 v[224:227], a[0:3], v[128:131], v[224:227]
  v_lshlrev_b32 v196, 16, v22
  v_and_b32 v197, s48, v22
  v_pk_fma_f32 v[108:109], v[196:197], v[144:145], v[108:109] op_sel_hi:[1,0,1]
  v_lshlrev_b32 v198, 16, v23
  v_and_b32 v199, s48, v23
  v_pk_fma_f32 v[110:111], v[198:199], v[144:145], v[110:111] op_sel_hi:[1,0,1]
  v_mfma_f32_16x16x32_bf16 v[228:231], a[16:19], v[128:131], v[228:231]
  s_waitcnt vmcnt(13)
  v_lshlrev_b32 v192, 16, v36
  v_and_b32 v193, s48, v36
  v_pk_fma_f32 v[104:105], v[192:193], v[146:147], v[104:105] op_sel_hi:[1,0,1]
  v_lshlrev_b32 v194, 16, v37
  v_and_b32 v195, s48, v37
  v_pk_fma_f32 v[106:107], v[194:195], v[146:147], v[106:107] op_sel_hi:[1,0,1]
  v_mfma_f32_16x16x32_bf16 v[232:235], a[32:35], v[128:131], v[232:235]
  v_lshlrev_b32 v196, 16, v38
  v_and_b32 v197, s48, v38
  v_pk_fma_f32 v[108:109], v[196:197], v[146:147], v[108:109] op_sel_hi:[1,0,1]
  v_lshlrev_b32 v198, 16, v39
  v_and_b32 v199, s48, v39
  v_pk_fma_f32 v[110:111], v[198:199], v[146:147], v[110:111] op_sel_hi:[1,0,1]
  v_mfma_f32_16x16x32_bf16 v[236:239], a[48:51], v[128:131], v[236:239]
  s_waitcnt vmcnt(12)
  v_lshlrev_b32 v192, 16, v52
  v_and_b32 v193, s48, v52
  v_pk_fma_f32 v[104:105], v[192:193], v[148:149], v[104:105] op_sel_hi:[1,0,1]
  v_lshlrev_b32 v194, 16, v53
  v_and_b32 v195, s48, v53
  v_pk_fma_f32 v[106:107], v[194:195], v[148:149], v[106:107] op_sel_hi:[1,0,1]
  v_mfma_f32_16x16x32_bf16 v[240:243], a[64:67], v[128:131], v[240:243]
  v_lshlrev_b32 v196, 16, v54
  v_and_b32 v197, s48, v54
  v_pk_fma_f32 v[108:109], v[196:197], v[148:149], v[108:109] op_sel_hi:[1,0,1]
  v_lshlrev_b32 v198, 16, v55
  v_and_b32 v199, s48, v55
  v_pk_fma_f32 v[110:111], v[198:199], v[148:149], v[110:111] op_sel_hi:[1,0,1]
  v_mfma_f32_16x16x32_bf16 v[244:247], a[80:83], v[128:131], v[244:247]
  s_waitcnt vmcnt(11)
  v_lshlrev_b32 v192, 16, v68
  v_and_b32 v193, s48, v68
  v_pk_fma_f32 v[104:105], v[192:193], v[150:151], v[104:105] op_sel_hi:[1,0,1]
  v_lshlrev_b32 v194, 16, v69
  v_and_b32 v195, s48, v69
  v_pk_fma_f32 v[106:107], v[194:195], v[150:151], v[106:107] op_sel_hi:[1,0,1]
  v_mfma_f32_16x16x32_bf16 v[248:251], a[96:99], v[128:131], v[248:251]
  v_lshlrev_b32 v196, 16, v70
  v_and_b32 v197, s48, v70
  v_pk_fma_f32 v[108:109], v[196:197], v[150:151], v[108:109] op_sel_hi:[1,0,1]
  v_lshlrev_b32 v198, 16, v71
  v_and_b32 v199, s48, v71
  v_pk_fma_f32 v[110:111], v[198:199], v[150:151], v[110:111] op_sel_hi:[1,0,1]
  v_mfma_f32_16x16x32_bf16 v[252:255], a[112:115], v[128:131], v[252:255]
  s_waitcnt vmcnt(10)
  v_lshlrev_b32 v192, 16, v84
  v_and_b32 v193, s48, v84
  v_pk_fma_f32 v[104:105], v[192:193], v[152:153], v[104:105] op_sel_hi:[1,0,1]
  v_lshlrev_b32 v194, 16, v85
  v_and_b32 v195, s48, v85
  v_pk_fma_f32 v[106:107], v[194:195], v[152:153], v[106:107] op_sel_hi:[1,0,1]
  v_lshlrev_b32 v196, 16, v86
  v_and_b32 v197, s48, v86
  v_pk_fma_f32 v[108:109], v[196:197], v[152:153], v[108:109] op_sel_hi:[1,0,1]
  v_lshlrev_b32 v198, 16, v87
  v_and_b32 v199, s48, v87
  v_pk_fma_f32 v[110:111], v[198:199], v[152:153], v[110:111] op_sel_hi:[1,0,1]
  v_cvt_pk_bf16_f32 v132, v104, v105
  v_cvt_pk_bf16_f32 v133, v106, v107
  v_cvt_pk_bf16_f32 v134, v108, v109
  v_cvt_pk_bf16_f32 v135, v110, v111
  s_waitcnt vmcnt(9)
  v_lshlrev_b32 v192, 16, v24
  v_and_b32 v193, s48, v24
  v_pk_fma_f32 v[112:113], v[192:193], v[144:145], v[112:113] op_sel_hi:[1,0,1]
  v_lshlrev_b32 v194, 16, v25
  v_and_b32 v195, s48, v25
  v_pk_fma_f32 v[114:115], v[194:195], v[144:145], v[114:115] op_sel_hi:[1,0,1]
  v_mfma_f32_16x16x32_bf16 v[224:227], a[4:7], v[132:135], v[224:227]
  v_lshlrev_b32 v196, 16, v26
  v_and_b32 v197, s48, v26
  v_pk_fma_f32 v[116:117], v[196:197], v[144:145], v[116:117] op_sel_hi:[1,0,1]
  v_lshlrev_b32 v198, 16, v27
  v_and_b32 v199, s48, v27
  v_pk_fma_f32 v[118:119], v[198:199], v[144:145], v[118:119] op_sel_hi:[1,0,1]
  v_mfma_f32_16x16x32_bf16 v[228:231], a[20:23], v[132:135], v[228:231]
  s_waitcnt vmcnt(8)
  v_lshlrev_b32 v192, 16, v40
  v_and_b32 v193, s48, v40
  v_pk_fma_f32 v[112:113], v[192:193], v[146:147], v[112:113] op_sel_hi:[1,0,1]
  v_lshlrev_b32 v194, 16, v41
  v_and_b32 v195, s48, v41
  v_pk_fma_f32 v[114:115], v[194:195], v[146:147], v[114:115] op_sel_hi:[1,0,1]
  v_mfma_f32_16x16x32_bf16 v[232:235], a[36:39], v[132:135], v[232:235]
  v_lshlrev_b32 v196, 16, v42
  v_and_b32 v197, s48, v42
  v_pk_fma_f32 v[116:117], v[196:197], v[146:147], v[116:117] op_sel_hi:[1,0,1]
  v_lshlrev_b32 v198, 16, v43
  v_and_b32 v199, s48, v43
  v_pk_fma_f32 v[118:119], v[198:199], v[146:147], v[118:119] op_sel_hi:[1,0,1]
  v_mfma_f32_16x16x32_bf16 v[236:239], a[52:55], v[132:135], v[236:239]
  s_waitcnt vmcnt(7)
  v_lshlrev_b32 v192, 16, v56
  v_and_b32 v193, s48, v56
  v_pk_fma_f32 v[112:113], v[192:193], v[148:149], v[112:113] op_sel_hi:[1,0,1]
  v_lshlrev_b32 v194, 16, v57
  v_and_b32 v195, s48, v57
  v_pk_fma_f32 v[114:115], v[194:195], v[148:149], v[114:115] op_sel_hi:[1,0,1]
  v_mfma_f32_16x16x32_bf16 v[240:243], a[68:71], v[132:135], v[240:243]
  v_lshlrev_b32 v196, 16, v58
  v_and_b32 v197, s48, v58
  v_pk_fma_f32 v[116:117], v[196:197], v[148:149], v[116:117] op_sel_hi:[1,0,1]
  v_lshlrev_b32 v198, 16, v59
  v_and_b32 v199, s48, v59
  v_pk_fma_f32 v[118:119], v[198:199], v[148:149], v[118:119] op_sel_hi:[1,0,1]
  v_mfma_f32_16x16x32_bf16 v[244:247], a[84:87], v[132:135], v[244:247]
  s_waitcnt vmcnt(6)
  v_lshlrev_b32 v192, 16, v72
  v_and_b32 v193, s48, v72
  v_pk_fma_f32 v[112:113], v[192:193], v[150:151], v[112:113] op_sel_hi:[1,0,1]
  v_lshlrev_b32 v194, 16, v73
  v_and_b32 v195, s48, v73
  v_pk_fma_f32 v[114:115], v[194:195], v[150:151], v[114:115] op_sel_hi:[1,0,1]
  v_mfma_f32_16x16x32_bf16 v[248:251], a[100:103], v[132:135], v[248:251]
  v_lshlrev_b32 v196, 16, v74
  v_and_b32 v197, s48, v74
  v_pk_fma_f32 v[116:117], v[196:197], v[150:151], v[116:117] op_sel_hi:[1,0,1]
  v_lshlrev_b32 v198, 16, v75
  v_and_b32 v199, s48, v75
  v_pk_fma_f32 v[118:119], v[198:199], v[150:151], v[118:119] op_sel_hi:[1,0,1]
  v_mfma_f32_16x16x32_bf16 v[252:255], a[116:119], v[132:135], v[252:255]
  s_waitcnt vmcnt(5)
  v_lshlrev_b32 v192, 16, v88
  v_and_b32 v193, s48, v88
  v_pk_fma_f32 v[112:113], v[192:193], v[152:153], v[112:113] op_sel_hi:[1,0,1]
  v_lshlrev_b32 v194, 16, v89
  v_and_b32 v195, s48, v89
  v_pk_fma_f32 v[114:115], v[194:195], v[152:153], v[114:115] op_sel_hi:[1,0,1]
  v_lshlrev_b32 v196, 16, v90
  v_and_b32 v197, s48, v90
  v_pk_fma_f32 v[116:117], v[196:197], v[152:153], v[116:117] op_sel_hi:[1,0,1]
  v_lshlrev_b32 v198, 16, v91
  v_and_b32 v199, s48, v91
  v_pk_fma_f32 v[118:119], v[198:199], v[152:153], v[118:119] op_sel_hi:[1,0,1]
  v_cvt_pk_bf16_f32 v136, v112, v113
  v_cvt_pk_bf16_f32 v137, v114, v115
  v_cvt_pk_bf16_f32 v138, v116, v117
  v_cvt_pk_bf16_f32 v139, v118, v119
  s_waitcnt vmcnt(4)
  v_lshlrev_b32 v192, 16, v28
  v_and_b32 v193, s48, v28
  v_pk_fma_f32 v[120:121], v[192:193], v[144:145], v[120:121] op_sel_hi:[1,0,1]
  v_lshlrev_b32 v194, 16, v29
  v_and_b32 v195, s48, v29
  v_pk_fma_f32 v[122:123], v[194:195], v[144:145], v[122:123] op_sel_hi:[1,0,1]
  v_mfma_f32_16x16x32_bf16 v[224:227], a[8:11], v[136:139], v[224:227]
  v_lshlrev_b32 v196, 16, v30
  v_and_b32 v197, s48, v30
  v_pk_fma_f32 v[124:125], v[196:197], v[144:145], v[124:125] op_sel_hi:[1,0,1]
  v_lshlrev_b32 v198, 16, v31
  v_and_b32 v199, s48, v31
  v_pk_fma_f32 v[126:127], v[198:199], v[144:145], v[126:127] op_sel_hi:[1,0,1]
  v_mfma_f32_16x16x32_bf16 v[228:231], a[24:27], v[136:139], v[228:231]
  s_waitcnt vmcnt(3)
  v_lshlrev_b32 v192, 16, v44
  v_and_b32 v193, s48, v44
  v_pk_fma_f32 v[120:121], v[192:193], v[146:147], v[120:121] op_sel_hi:[1,0,1]
  v_lshlrev_b32 v194, 16, v45
  v_and_b32 v195, s48, v45
  v_pk_fma_f32 v[122:123], v[194:195], v[146:147], v[122:123] op_sel_hi:[1,0,1]
  v_mfma_f32_16x16x32_bf16 v[232:235], a[40:43], v[136:139], v[232:235]
  v_lshlrev_b32 v196, 16, v46
  v_and_b32 v197, s48, v46
  v_pk_fma_f32 v[124:125], v[196:197], v[146:147], v[124:125] op_sel_hi:[1,0,1]
  v_lshlrev_b32 v198, 16, v47
  v_and_b32 v199, s48, v47
  v_pk_fma_f32 v[126:127], v[198:199], v[146:147], v[126:127] op_sel_hi:[1,0,1]
  v_mfma_f32_16x16x32_bf16 v[236:239], a[56:59], v[136:139], v[236:239]
  s_waitcnt vmcnt(2)
  v_lshlrev_b32 v192, 16, v60
  v_and_b32 v193, s48, v60
  v_pk_fma_f32 v[120:121], v[192:193], v[148:149], v[120:121] op_sel_hi:[1,0,1]
  v_lshlrev_b32 v194, 16, v61
  v_and_b32 v195, s48, v61
  v_pk_fma_f32 v[122:123], v[194:195], v[148:149], v[122:123] op_sel_hi:[1,0,1]
  v_mfma_f32_16x16x32_bf16 v[240:243], a[72:75], v[136:139], v[240:243]
  v_lshlrev_b32 v196, 16, v62
  v_and_b32 v197, s48, v62
  v_pk_fma_f32 v[124:125], v[196:197], v[148:149], v[124:125] op_sel_hi:[1,0,1]
  v_lshlrev_b32 v198, 16, v63
  v_and_b32 v199, s48, v63
  v_pk_fma_f32 v[126:127], v[198:199], v[148:149], v[126:127] op_sel_hi:[1,0,1]
  v_mfma_f32_16x16x32_bf16 v[244:247], a[88:91], v[136:139], v[244:247]
  s_waitcnt vmcnt(1)
  v_lshlrev_b32 v192, 16, v76
  v_and_b32 v193, s48, v76
  v_pk_fma_f32 v[120:121], v[192:193], v[150:151], v[120:121] op_sel_hi:[1,0,1]
  v_lshlrev_b32 v194, 16, v77
  v_and_b32 v195, s48, v77
  v_pk_fma_f32 v[122:123], v[194:195], v[150:151], v[122:123] op_sel_hi:[1,0,1]
  v_mfma_f32_16x16x32_bf16 v[248:251], a[104:107], v[136:139], v[248:251]
  v_lshlrev_b32 v196, 16, v78
  v_and_b32 v197, s48, v78
  v_pk_fma_f32 v[124:125], v[196:197], v[150:151], v[124:125] op_sel_hi:[1,0,1]
  v_lshlrev_b32 v198, 16, v79
  v_and_b32 v199, s48, v79
  v_pk_fma_f32 v[126:127], v[198:199], v[150:151], v[126:127] op_sel_hi:[1,0,1]
  v_mfma_f32_16x16x32_bf16 v[252:255], a[120:123], v[136:139], v[252:255]
  s_waitcnt vmcnt(0)
  v_lshlrev_b32 v192, 16, v92
  v_and_b32 v193, s48, v92
  v_pk_fma_f32 v[120:121], v[192:193], v[152:153], v[120:121] op_sel_hi:[1,0,1]
  v_lshlrev_b32 v194, 16, v93
  v_and_b32 v195, s48, v93
  v_pk_fma_f32 v[122:123], v[194:195], v[152:153], v[122:123] op_sel_hi:[1,0,1]
  v_lshlrev_b32 v196, 16, v94
  v_and_b32 v197, s48, v94
  v_pk_fma_f32 v[124:125], v[196:197], v[152:153], v[124:125] op_sel_hi:[1,0,1]
  v_lshlrev_b32 v198, 16, v95
  v_and_b32 v199, s48, v95
  v_pk_fma_f32 v[126:127], v[198:199], v[152:153], v[126:127] op_sel_hi:[1,0,1]
  v_cvt_pk_bf16_f32 v140, v120, v121
  v_cvt_pk_bf16_f32 v141, v122, v123
  v_cvt_pk_bf16_f32 v142, v124, v125
  v_cvt_pk_bf16_f32 v143, v126, v127
  s_nop 1
  v_mfma_f32_16x16x32_bf16 v[224:227], a[12:15], v[140:143], v[224:227]
  v_mfma_f32_16x16x32_bf16 v[228:231], a[28:31], v[140:143], v[228:231]
  v_mfma_f32_16x16x32_bf16 v[232:235], a[44:47], v[140:143], v[232:235]
  v_mfma_f32_16x16x32_bf16 v[236:239], a[60:63], v[140:143], v[236:239]
  v_mfma_f32_16x16x32_bf16 v[240:243], a[76:79], v[140:143], v[240:243]
  v_mfma_f32_16x16x32_bf16 v[244:247], a[92:95], v[140:143], v[244:247]
  v_mfma_f32_16x16x32_bf16 v[248:251], a[108:111], v[140:143], v[248:251]
  v_mfma_f32_16x16x32_bf16 v[252:255], a[124:127], v[140:143], v[252:255]
  s_nop 0
  v_cvt_pk_bf16_f32 v16, v224, v225
  v_cvt_pk_bf16_f32 v17, v226, v227
  v_cvt_pk_bf16_f32 v18, v228, v229
  v_cvt_pk_bf16_f32 v19, v230, v231
  buffer_store_dwordx4 v[16:19], v12, s[20:23], s38 offen offset:0 sc1
  v_cvt_pk_bf16_f32 v20, v232, v233
  v_cvt_pk_bf16_f32 v21, v234, v235
  v_cvt_pk_bf16_f32 v22, v236, v237
  v_cvt_pk_bf16_f32 v23, v238, v239
  buffer_store_dwordx4 v[20:23], v12, s[20:23], s38 offen offset:64 sc1
  v_cvt_pk_bf16_f32 v24, v240, v241
  v_cvt_pk_bf16_f32 v25, v242, v243
  v_cvt_pk_bf16_f32 v26, v244, v245
  v_cvt_pk_bf16_f32 v27, v246, v247
  buffer_store_dwordx4 v[24:27], v12, s[20:23], s38 offen offset:128 sc1
  v_cvt_pk_bf16_f32 v28, v248, v249
  v_cvt_pk_bf16_f32 v29, v250, v251
  v_cvt_pk_bf16_f32 v30, v252, v253
  v_cvt_pk_bf16_f32 v31, v254, v255
  buffer_store_dwordx4 v[28:31], v12, s[20:23], s38 offen offset:192 sc1
  s_endpgm
Lk2_nofinal:
  s_waitcnt vmcnt(11)
  buffer_store_dword v15, v13, s[28:31], s79 offen offset:32 sc1
  s_waitcnt vmcnt(7)
  buffer_store_dword v15, v13, s[28:31], s79 offen offset:64 sc1
  s_waitcnt vmcnt(3)
  buffer_store_dword v15, v13, s[28:31], s79 offen offset:96 sc1
  s_endpgm
Lk2_w_rare:
  v_mov_b32 v9, 0
  s_mov_b32 s46, 59782912
  s_mov_b32 s47, 0
Lk2_w_poll:
  buffer_load_dword v10, v9, s[28:31], s46 offen sc1
  s_add_u32 s47, s47, 1
  s_waitcnt vmcnt(0)
  v_readfirstlane_b32 s48, v10
  s_cmp_gt_u32 s47, 1048576
  s_cbranch_scc1 Lk2_w_go
  s_cmp_lt_u32 s48, 16
  s_cbranch_scc1 Lk2_w_poll
Lk2_w_go:
  s_sub_u32 s46, s32, 65536
  s_add_u32 s46, s46, 11665408
  s_mov_b32 m0, s32
  s_mov_b32 s47, 0
Lk2_w_loop:
  buffer_load_dwordx4 v4, s[28:31], s46 offen sc1 lds
  s_add_u32 m0, m0, 1024
  s_add_u32 s46, s46, 1024
  s_add_u32 s47, s47, 1
  s_cmp_lt_u32 s47, 16
  s_cbranch_scc1 Lk2_w_loop
  s_lshr_b32 s46, s33, 1
  s_lshl_b32 s46, s46, 12
  s_and_b32 s3, s33, 1
  s_lshl_b32 s4, s3, 11
  s_add_u32 s4, s4, s46
  s_add_u32 m0, s4, 154688
  s_lshl_b32 s3, s3, 7
  s_add_u32 s46, s46, s3
  s_add_u32 s46, s46, 11583488
  buffer_load_dwordx4 v242, s[28:31], s46 offen lds
  s_add_u32 m0, m0, 960
  s_min_u32 s3, s36, 783
  buffer_load_dwordx4 v242, s[28:31], s46 offen offset:64 lds
  s_mov_b32 m0, s49
  s_lshl_b32 s3, s3, 12
  s_add_u32 s3, s3, 4194304
  buffer_load_dwordx4 v4, s[28:31], s3 offen offset:0 lds
  buffer_load_dwordx4 v4, s[28:31], s3 offen offset:1024 lds
  buffer_load_dwordx4 v4, s[28:31], s3 offen offset:2048 lds
  buffer_load_dwordx4 v4, s[28:31], s3 offen offset:3072 lds
  s_waitcnt vmcnt(0)
  s_branch Lk2_w_done
Lk2_redo:
  s_mov_b32 s45, 1
  s_mov_b32 s66, 0
  s_mov_b32 s61, -1
  s_mov_b32 s71, 0
  s_waitcnt vmcnt(0) lgkmcnt(0)
  s_barrier
  s_lshl_b32 s41, s33, 12
  s_mov_b32 s46, 0
  s_mov_b32 s47, s68
  s_mov_b32 s48, 0xff800000
  v_mov_b32 v7, v5
  v_mov_b32 v160, s48
  v_mov_b32 v161, s48
  v_mov_b32 v162, s48
  v_mov_b32 v163, s48
  v_mov_b32 v208, 0
  v_mov_b32 v209, 0
  v_mov_b32 v210, 0
  v_mov_b32 v211, 0
  v_mov_b32 v212, 0
  v_mov_b32 v213, 0
  v_mov_b32 v214, 0
  v_mov_b32 v215, 0
  v_mov_b32 v216, 0
  v_mov_b32 v217, 0
  v_mov_b32 v218, 0
  v_mov_b32 v219, 0
  v_mov_b32 v220, 0
  v_mov_b32 v221, 0
  v_mov_b32 v222, 0
  v_mov_b32 v223, 0
Lk2_mx_loop:
  s_max_u32 s40, s46, 5
  s_lshl_b32 s40, s40, 2
  s_add_u32 s40, s40, 153644
  v_mov_b32 v9, s40
  ds_read_b32 v9, v9
  s_waitcnt lgkmcnt(0)
  v_readfirstlane_b32 s69, v9
  s_nop 0
  s_and_b32 s69, s69, 0xffff
  s_add_u32 s40, s70, s46
  s_cmp_lt_u32 s46, 5
  s_cselect_b32 s69, s40, s69
  s_lshl_b32 s40, s69, 14
  s_add_u32 s40, s40, s39
  s_mov_b32 m0, s41
  s_nop 0
  buffer_load_dwordx4 v242, s[28:31], s40 offen offset:0 lds
  s_add_u32 m0, m0, 960
  s_nop 0
  buffer_load_dwordx4 v242, s[28:31], s40 offen offset:64 lds
  s_add_u32 m0, m0, 960
  s_nop 0
  buffer_load_dwordx4 v242, s[28:31], s40 offen offset:128 lds
  s_add_u32 m0, m0, 960
  s_nop 0
  buffer_load_dwordx4 v242, s[28:31], s40 offen offset:192 lds
  s_waitcnt vmcnt(0)
  s_barrier
  ds_read_b128 a[64:67], v7 offset:0
  ds_read_b128 a[68:71], v7 offset:1024
  ds_read_b128 a[72:75], v7 offset:2048
  ds_read_b128 a[76:79], v7 offset:3072
  ds_read_b128 a[80:83], v7 offset:4096
  ds_read_b128 a[84:87], v7 offset:5120
  ds_read_b128 a[88:91], v7 offset:6144
  ds_read_b128 a[92:95], v7 offset:7168
  ds_read_b128 a[96:99], v7 offset:8192
  ds_read_b128 a[100:103], v7 offset:9216
  ds_read_b128 a[104:107], v7 offset:10240
  ds_read_b128 a[108:111], v7 offset:11264
  ds_read_b128 a[112:115], v7 offset:12288
  ds_read_b128 a[116:119], v7 offset:13312
  ds_read_b128 a[120:123], v7 offset:14336
  ds_read_b128 a[124:127], v7 offset:15360
  s_waitcnt lgkmcnt(0)
  s_barrier
  v_mfma_f32_16x16x32_bf16 v[16:19], a[64:67], a[0:3], v[208:211]
  v_mfma_f32_16x16x32_bf16 v[16:19], a[68:71], a[4:7], v[16:19]
  v_mfma_f32_16x16x32_bf16 v[16:19], a[72:75], a[8:11], v[16:19]
  v_mfma_f32_16x16x32_bf16 v[16:19], a[76:79], a[12:15], v[16:19]
  v_mfma_f32_16x16x32_bf16 v[20:23], a[80:83], a[0:3], v[212:215]
  v_mfma_f32_16x16x32_bf16 v[20:23], a[84:87], a[4:7], v[20:23]
  v_mfma_f32_16x16x32_bf16 v[20:23], a[88:91], a[8:11], v[20:23]
  v_mfma_f32_16x16x32_bf16 v[20:23], a[92:95], a[12:15], v[20:23]
  v_mfma_f32_16x16x32_bf16 v[24:27], a[96:99], a[0:3], v[216:219]
  v_mfma_f32_16x16x32_bf16 v[24:27], a[100:103], a[4:7], v[24:27]
  v_mfma_f32_16x16x32_bf16 v[24:27], a[104:107], a[8:11], v[24:27]
  v_mfma_f32_16x16x32_bf16 v[24:27], a[108:111], a[12:15], v[24:27]
  v_mfma_f32_16x16x32_bf16 v[28:31], a[112:115], a[0:3], v[220:223]
  v_mfma_f32_16x16x32_bf16 v[28:31], a[116:119], a[4:7], v[28:31]
  v_mfma_f32_16x16x32_bf16 v[28:31], a[120:123], a[8:11], v[28:31]
  v_mfma_f32_16x16x32_bf16 v[28:31], a[124:127], a[12:15], v[28:31]
  v_mfma_f32_16x16x32_bf16 v[32:35], a[64:67], a[16:19], v[208:211]
  v_mfma_f32_16x16x32_bf16 v[32:35], a[68:71], a[20:23], v[32:35]
  v_mfma_f32_16x16x32_bf16 v[32:35], a[72:75], a[24:27], v[32:35]
  v_mfma_f32_16x16x32_bf16 v[32:35], a[76:79], a[28:31], v[32:35]
  v_mfma_f32_16x16x32_bf16 v[36:39], a[80:83], a[16:19], v[212:215]
  v_mfma_f32_16x16x32_bf16 v[36:39], a[84:87], a[20:23], v[36:39]
  v_mfma_f32_16x16x32_bf16 v[36:39], a[88:91], a[24:27], v[36:39]
  v_mfma_f32_16x16x32_bf16 v[36:39], a[92:95], a[28:31], v[36:39]
  v_mfma_f32_16x16x32_bf16 v[40:43], a[96:99], a[16:19], v[216:219]
  v_mfma_f32_16x16x32_bf16 v[40:43], a[100:103], a[20:23], v[40:43]
  v_mfma_f32_16x16x32_bf16 v[40:43], a[104:107], a[24:27], v[40:43]
  v_mfma_f32_16x16x32_bf16 v[40:43], a[108:111], a[28:31], v[40:43]
  v_mfma_f32_16x16x32_bf16 v[44:47], a[112:115], a[16:19], v[220:223]
  v_mfma_f32_16x16x32_bf16 v[44:47], a[116:119], a[20:23], v[44:47]
  v_mfma_f32_16x16x32_bf16 v[44:47], a[120:123], a[24:27], v[44:47]
  v_mfma_f32_16x16x32_bf16 v[44:47], a[124:127], a[28:31], v[44:47]
  v_mfma_f32_16x16x32_bf16 v[48:51], a[64:67], a[32:35], v[208:211]
  v_mfma_f32_16x16x32_bf16 v[48:51], a[68:71], a[36:39], v[48:51]
  v_mfma_f32_16x16x32_bf16 v[48:51], a[72:75], a[40:43], v[48:51]
  v_mfma_f32_16x16x32_bf16 v[48:51], a[76:79], a[44:47], v[48:51]
  v_mfma_f32_16x16x32_bf16 v[52:55], a[80:83], a[32:35], v[212:215]
  v_mfma_f32_16x16x32_bf16 v[52:55], a[84:87], a[36:39], v[52:55]
  v_mfma_f32_16x16x32_bf16 v[52:55], a[88:91], a[40:43], v[52:55]
  v_mfma_f32_16x16x32_bf16 v[52:55], a[92:95], a[44:47], v[52:55]
  v_mfma_f32_16x16x32_bf16 v[56:59], a[96:99], a[32:35], v[216:219]
  v_mfma_f32_16x16x32_bf16 v[56:59], a[100:103], a[36:39], v[56:59]
  v_mfma_f32_16x16x32_bf16 v[56:59], a[104:107], a[40:43], v[56:59]
  v_mfma_f32_16x16x32_bf16 v[56:59], a[108:111], a[44:47], v[56:59]
  v_mfma_f32_16x16x32_bf16 v[60:63], a[112:115], a[32:35], v[220:223]
  v_mfma_f32_16x16x32_bf16 v[60:63], a[116:119], a[36:39], v[60:63]
  v_mfma_f32_16x16x32_bf16 v[60:63], a[120:123], a[40:43], v[60:63]
  v_mfma_f32_16x16x32_bf16 v[60:63], a[124:127], a[44:47], v[60:63]
  v_mfma_f32_16x16x32_bf16 v[64:67], a[64:67], a[48:51], v[208:211]
  v_mfma_f32_16x16x32_bf16 v[64:67], a[68:71], a[52:55], v[64:67]
  v_mfma_f32_16x16x32_bf16 v[64:67], a[72:75], a[56:59], v[64:67]
  v_mfma_f32_16x16x32_bf16 v[64:67], a[76:79], a[60:63], v[64:67]
  v_mfma_f32_16x16x32_bf16 v[68:71], a[80:83], a[48:51], v[212:215]
  v_mfma_f32_16x16x32_bf16 v[68:71], a[84:87], a[52:55], v[68:71]
  v_mfma_f32_16x16x32_bf16 v[68:71], a[88:91], a[56:59], v[68:71]
  v_mfma_f32_16x16x32_bf16 v[68:71], a[92:95], a[60:63], v[68:71]
  v_mfma_f32_16x16x32_bf16 v[72:75], a[96:99], a[48:51], v[216:219]
  v_mfma_f32_16x16x32_bf16 v[72:75], a[100:103], a[52:55], v[72:75]
  v_mfma_f32_16x16x32_bf16 v[72:75], a[104:107], a[56:59], v[72:75]
  v_mfma_f32_16x16x32_bf16 v[72:75], a[108:111], a[60:63], v[72:75]
  v_mfma_f32_16x16x32_bf16 v[76:79], a[112:115], a[48:51], v[220:223]
  v_mfma_f32_16x16x32_bf16 v[76:79], a[116:119], a[52:55], v[76:79]
  v_mfma_f32_16x16x32_bf16 v[76:79], a[120:123], a[56:59], v[76:79]
  v_mfma_f32_16x16x32_bf16 v[76:79], a[124:127], a[60:63], v[76:79]
  v_max3_f32 v160, v160, v16, v17
  v_max3_f32 v160, v160, v18, v19
  v_max3_f32 v160, v160, v20, v21
  v_max3_f32 v160, v160, v22, v23
  v_max3_f32 v160, v160, v24, v25
  v_max3_f32 v160, v160, v26, v27
  v_max3_f32 v160, v160, v28, v29
  v_max3_f32 v160, v160, v30, v31
  v_max3_f32 v161, v161, v32, v33
  v_max3_f32 v161, v161, v34, v35
  v_max3_f32 v161, v161, v36, v37
  v_max3_f32 v161, v161, v38, v39
  v_max3_f32 v161, v161, v40, v41
  v_max3_f32 v161, v161, v42, v43
  v_max3_f32 v161, v161, v44, v45
  v_max3_f32 v161, v161, v46, v47
  v_max3_f32 v162, v162, v48, v49
  v_max3_f32 v162, v162, v50, v51
  v_max3_f32 v162, v162, v52, v53
  v_max3_f32 v162, v162, v54, v55
  v_max3_f32 v162, v162, v56, v57
  v_max3_f32 v162, v162, v58, v59
  v_max3_f32 v162, v162, v60, v61
  v_max3_f32 v162, v162, v62, v63
  v_max3_f32 v163, v163, v64, v65
  v_max3_f32 v163, v163, v66, v67
  v_max3_f32 v163, v163, v68, v69
  v_max3_f32 v163, v163, v70, v71
  v_max3_f32 v163, v163, v72, v73
  v_max3_f32 v163, v163, v74, v75
  v_max3_f32 v163, v163, v76, v77
  v_max3_f32 v163, v163, v78, v79
  s_add_u32 s46, s46, 1
  s_cmp_lt_u32 s46, s47
  s_nop 7
  s_cbranch_scc1 Lk2_mx_loop
  v_mov_b32 v9, v160
  s_nop 1
  v_permlane16_swap_b32 v160, v9
  v_max_f32 v160, v160, v9
  v_mov_b32 v9, v160
  s_nop 1
  v_permlane32_swap_b32 v160, v9
  v_max_f32 v160, v160, v9
  v_sub_f32 v192, 0, v160
  v_mov_b32 v9, v161
  s_nop 1
  v_permlane16_swap_b32 v161, v9
  v_max_f32 v161, v161, v9
  v_mov_b32 v9, v161
  s_nop 1
  v_permlane32_swap_b32 v161, v9
  v_max_f32 v161, v161, v9
  v_sub_f32 v196, 0, v161
  v_mov_b32 v9, v162
  s_nop 1
  v_permlane16_swap_b32 v162, v9
  v_max_f32 v162, v162, v9
  v_mov_b32 v9, v162
  s_nop 1
  v_permlane32_swap_b32 v162, v9
  v_max_f32 v162, v162, v9
  v_sub_f32 v200, 0, v162
  v_mov_b32 v9, v163
  s_nop 1
  v_permlane16_swap_b32 v163, v9
  v_max_f32 v163, v163, v9
  v_mov_b32 v9, v163
  s_nop 1
  v_permlane32_swap_b32 v163, v9
  v_max_f32 v163, v163, v9
  v_sub_f32 v204, 0, v163
  s_branch Lk2_run
Lk2_g_rare:
  s_waitcnt vmcnt(0)
  s_mov_b32 s59, 0
  s_mov_b32 s54, s32
  s_add_u32 s65, s32, 4096
  s_mov_b32 s67, 0
  v_accvgpr_write_b32 a192, 0
  v_accvgpr_write_b32 a193, 0
  v_accvgpr_write_b32 a194, 0
  v_accvgpr_write_b32 a195, 0
  v_accvgpr_write_b32 a196, 0
  v_accvgpr_write_b32 a197, 0
  v_accvgpr_write_b32 a198, 0
  v_accvgpr_write_b32 a199, 0
  v_accvgpr_write_b32 a200, 0
  v_accvgpr_write_b32 a201, 0
  v_accvgpr_write_b32 a202, 0
  v_accvgpr_write_b32 a203, 0
  v_accvgpr_write_b32 a204, 0
  v_accvgpr_write_b32 a205, 0
  v_accvgpr_write_b32 a206, 0
  v_accvgpr_write_b32 a207, 0
  v_accvgpr_write_b32 a208, 0
  v_accvgpr_write_b32 a209, 0
  v_accvgpr_write_b32 a210, 0
  v_accvgpr_write_b32 a211, 0
  v_accvgpr_write_b32 a212, 0
  v_accvgpr_write_b32 a213, 0
  v_accvgpr_write_b32 a214, 0
  v_accvgpr_write_b32 a215, 0
  v_accvgpr_write_b32 a216, 0
  v_accvgpr_write_b32 a217, 0
  v_accvgpr_write_b32 a218, 0
  v_accvgpr_write_b32 a219, 0
  v_accvgpr_write_b32 a220, 0
  v_accvgpr_write_b32 a221, 0
  v_accvgpr_write_b32 a222, 0
  v_accvgpr_write_b32 a223, 0
  v_and_b32 v9, 1, v2
  v_lshlrev_b32 v9, 3, v9
  v_xor_b32 v10, v9, v3
  v_lshlrev_b32 v10, 4, v10
  v_xor_b32 v216, 0, v10
  v_add_u32 v216, 3072, v216
  v_xor_b32 v217, 32, v10
  v_add_u32 v217, 2048, v217
  v_xor_b32 v218, 64, v10
  v_add_u32 v218, 1024, v218
  v_xor_b32 v219, 96, v10
  v_add_u32 v219, 0, v219
  v_bfe_u32 v10, v1, 2, 2
  v_lshl_add_u32 v11, v10, 2, v2
  v_lshlrev_b32 v11, 8, v11
  v_lshlrev_b32 v10, 1, v10
  v_xor_b32 v9, v9, v10
  v_bfe_u32 v10, v1, 1, 1
  v_xor_b32 v9, v9, v10
  v_lshl_add_u32 v11, v9, 4, v11
  v_and_b32 v10, 1, v1
  v_lshl_add_u32 v11, v10, 3, v11
  v_add_u32 v11, s54, v11
  v_xor_b32 v220, 0, v11
  v_xor_b32 v221, 32, v11
  v_xor_b32 v222, 64, v11
  v_xor_b32 v223, 96, v11
  v_xor_b32 v224, 128, v11
  v_xor_b32 v225, 160, v11
  v_xor_b32 v226, 192, v11
  v_xor_b32 v227, 224, v11
  v_add_u32 v15, 18, v3
Lk2_g_slow:
  s_waitcnt vmcnt(0) lgkmcnt(0)
  v_cmp_lt_u32 vcc, s59, v239
  s_cbranch_vccz Lk2_g_back
  v_mov_b32 v232, 0xffff
  v_mov_b32 v233, 0xffff
  v_mov_b32 v234, 0xffff
  v_mov_b32 v235, 0xffff
  s_lshl_b32 s46, s59, 4
  s_add_u32 s46, s46, s60
  s_mov_b64 exec, vcc
  buffer_load_dwordx4 v[232:235], v238, s[28:31], s46 offen
  s_mov_b64 exec, -1
  v_add_u32 v9, s54, v4
  s_waitcnt vmcnt(0)
  ds_write_b128 v9, v[232:235] offset:8192
  s_add_u32 s59, s59, 1
  s_mov_b32 s47, 8
  v_lshlrev_b32 v11, 5, v2
  v_add_u32 v11, s54, v11
  s_waitcnt lgkmcnt(0)
Lk2_g_loop:
  ds_read_b128 v[208:211], v11 offset:8192
  ds_read_b128 v[212:215], v11 offset:8208
  v_add_u32 v11, 128, v11
  s_mov_b32 m0, s54
  s_waitcnt lgkmcnt(1)
  v_mad_u32_u16 v248, v208, s55, v216
  buffer_load_dwordx4 v248, s[20:23], 0 offen offset:0 sc1 lds
  v_mad_u32_u16 v249, v209, s55, v217
  buffer_load_dwordx4 v249, s[20:23], 0 offen offset:1024 sc1 lds
  v_mad_u32_u16 v250, v210, s55, v218
  buffer_load_dwordx4 v250, s[20:23], 0 offen offset:2048 sc1 lds
  v_mad_u32_u16 v251, v211, s55, v219
  buffer_load_dwordx4 v251, s[20:23], 0 offen offset:3072 sc1 lds
  s_mov_b32 m0, s65
  s_waitcnt lgkmcnt(0)
  v_mad_u32_u16 v252, v212, s55, v216
  buffer_load_dwordx4 v252, s[20:23], 0 offen offset:0 sc1 lds
  v_mad_u32_u16 v253, v213, s55, v217
  buffer_load_dwordx4 v253, s[20:23], 0 offen offset:1024 sc1 lds
  v_mad_u32_u16 v254, v214, s55, v218
  buffer_load_dwordx4 v254, s[20:23], 0 offen offset:2048 sc1 lds
  v_mad_u32_u16 v255, v215, s55, v219
  buffer_load_dwordx4 v255, s[20:23], 0 offen offset:3072 sc1 lds
  v_perm_b32 v228, v209, v208, s58
  v_alignbit_b32 v228, v228, v228, v15
  v_and_b32 v228, s57, v228
  v_perm_b32 v229, v211, v210, s58
  v_alignbit_b32 v229, v229, v229, v15
  v_and_b32 v229, s57, v229
  v_perm_b32 v230, v213, v212, s58
  v_alignbit_b32 v230, v230, v230, v15
  v_and_b32 v230, s57, v230
  v_perm_b32 v231, v215, v214, s58
  v_alignbit_b32 v231, v231, v231, v15
  v_and_b32 v231, s57, v231
  s_waitcnt vmcnt(0)
  ds_read_b64_tr_b16 a[224:225], v220 offset:0
  ds_read_b64_tr_b16 a[226:227], v220 offset:4096
  ds_read_b64_tr_b16 a[228:229], v221 offset:0
  ds_read_b64_tr_b16 a[230:231], v221 offset:4096
  ds_read_b64_tr_b16 a[232:233], v222 offset:0
  ds_read_b64_tr_b16 a[234:235], v222 offset:4096
  ds_read_b64_tr_b16 a[236:237], v223 offset:0
  ds_read_b64_tr_b16 a[238:239], v223 offset:4096
  ds_read_b64_tr_b16 a[240:241], v224 offset:0
  ds_read_b64_tr_b16 a[242:243], v224 offset:4096
  ds_read_b64_tr_b16 a[244:245], v225 offset:0
  ds_read_b64_tr_b16 a[246:247], v225 offset:4096
  ds_read_b64_tr_b16 a[248:249], v226 offset:0
  ds_read_b64_tr_b16 a[250:251], v226 offset:4096
  ds_read_b64_tr_b16 a[252:253], v227 offset:0
  ds_read_b64_tr_b16 a[254:255], v227 offset:4096
  s_waitcnt lgkmcnt(14)
  v_mfma_f32_16x16x32_bf16 a[192:195], a[224:227], v[228:231], a[192:195]
  s_waitcnt lgkmcnt(12)
  v_mfma_f32_16x16x32_bf16 a[196:199], a[228:231], v[228:231], a[196:199]
  s_waitcnt lgkmcnt(10)
  v_mfma_f32_16x16x32_bf16 a[200:203], a[232:235], v[228:231], a[200:203]
  s_waitcnt lgkmcnt(8)
  v_mfma_f32_16x16x32_bf16 a[204:207], a[236:239], v[228:231], a[204:207]
  s_waitcnt lgkmcnt(6)
  v_mfma_f32_16x16x32_bf16 a[208:211], a[240:243], v[228:231], a[208:211]
  s_waitcnt lgkmcnt(4)
  v_mfma_f32_16x16x32_bf16 a[212:215], a[244:247], v[228:231], a[212:215]
  s_waitcnt lgkmcnt(2)
  v_mfma_f32_16x16x32_bf16 a[216:219], a[248:251], v[228:231], a[216:219]
  s_waitcnt lgkmcnt(0)
  v_mfma_f32_16x16x32_bf16 a[220:223], a[252:255], v[228:231], a[220:223]
  s_sub_u32 s47, s47, 1
  s_cmp_lg_u32 s47, 0
  s_cbranch_scc1 Lk2_g_loop
  s_branch Lk2_g_slow
Lk2_g_back:
  s_nop 7
  s_branch Lk2_g_done
Lk2_wprep:
  s_load_dwordx2 s[4:5], s[0:1], 32
  s_load_dwordx2 s[6:7], s[0:1], 56
  s_load_dwordx2 s[8:9], s[0:1], 64
  s_load_dwordx2 s[12:13], s[0:1], 88
  v_and_b32 v1, 63, v0
  v_lshrrev_b32 v2, 4, v1
  v_and_b32 v3, 15, v1
  v_lshrrev_b32 v7, 6, v0
  s_sub_u32 s34, s2, 245
  s_lshl_b32 s34, s34, 2
  v_readfirstlane_b32 s33, v7
  s_nop 0
  s_add_u32 s34, s34, s33
  s_and_b32 s35, s34, 7
  s_waitcnt lgkmcnt(0)
  s_cmp_ge_u32 s34, 8
  s_cselect_b32 s4, s6, s4
  s_cselect_b32 s5, s7, s5
  s_mov_b32 s16, s4
  s_and_b32 s17, s5, 0xffff
  s_mov_b32 s18, 32768
  s_mov_b32 s19, 0x20000
  s_mov_b32 s20, s8
  s_and_b32 s21, s9, 0xffff
  s_mov_b32 s22, 32768
  s_mov_b32 s23, 0x20000
  s_mov_b32 s28, s12
  s_and_b32 s29, s13, 0xffff
  s_mov_b32 s30, 67108864
  s_mov_b32 s31, 0x20000
  v_lshlrev_b32 v4, 8, v3
  v_lshl_add_u32 v4, v2, 4, v4
  s_mov_b32 s36, 0
  buffer_load_dwordx4 v[16:19], v4, s[16:19], s36 offen offset:0
  buffer_load_dwordx4 v[20:23], v4, s[16:19], s36 offen offset:64
  buffer_load_dwordx4 v[24:27], v4, s[16:19], s36 offen offset:128
  buffer_load_dwordx4 v[28:31], v4, s[16:19], s36 offen offset:192
  s_add_u32 s36, s36, 4096
  buffer_load_dwordx4 v[32:35], v4, s[16:19], s36 offen offset:0
  buffer_load_dwordx4 v[36:39], v4, s[16:19], s36 offen offset:64
  buffer_load_dwordx4 v[40:43], v4, s[16:19], s36 offen offset:128
  buffer_load_dwordx4 v[44:47], v4, s[16:19], s36 offen offset:192
  s_add_u32 s36, s36, 4096
  buffer_load_dwordx4 v[48:51], v4, s[16:19], s36 offen offset:0
  buffer_load_dwordx4 v[52:55], v4, s[16:19], s36 offen offset:64
  buffer_load_dwordx4 v[56:59], v4, s[16:19], s36 offen offset:128
  buffer_load_dwordx4 v[60:63], v4, s[16:19], s36 offen offset:192
  s_add_u32 s36, s36, 4096
  buffer_load_dwordx4 v[64:67], v4, s[16:19], s36 offen offset:0
  buffer_load_dwordx4 v[68:71], v4, s[16:19], s36 offen offset:64
  buffer_load_dwordx4 v[72:75], v4, s[16:19], s36 offen offset:128
  buffer_load_dwordx4 v[76:79], v4, s[16:19], s36 offen offset:192
  s_add_u32 s36, s36, 4096
  buffer_load_dwordx4 v[80:83], v4, s[16:19], s36 offen offset:0
  buffer_load_dwordx4 v[84:87], v4, s[16:19], s36 offen offset:64
  buffer_load_dwordx4 v[88:91], v4, s[16:19], s36 offen offset:128
  buffer_load_dwordx4 v[92:95], v4, s[16:19], s36 offen offset:192
  s_add_u32 s36, s36, 4096
  buffer_load_dwordx4 v[96:99], v4, s[16:19], s36 offen offset:0
  buffer_load_dwordx4 v[100:103], v4, s[16:19], s36 offen offset:64
  buffer_load_dwordx4 v[104:107], v4, s[16:19], s36 offen offset:128
  buffer_load_dwordx4 v[108:111], v4, s[16:19], s36 offen offset:192
  s_add_u32 s36, s36, 4096
  buffer_load_dwordx4 v[112:115], v4, s[16:19], s36 offen offset:0
  buffer_load_dwordx4 v[116:119], v4, s[16:19], s36 offen offset:64
  buffer_load_dwordx4 v[120:123], v4, s[16:19], s36 offen offset:128
  buffer_load_dwordx4 v[124:127], v4, s[16:19], s36 offen offset:192
  s_add_u32 s36, s36, 4096
  buffer_load_dwordx4 v[128:131], v4, s[16:19], s36 offen offset:0
  buffer_load_dwordx4 v[132:135], v4, s[16:19], s36 offen offset:64
  buffer_load_dwordx4 v[136:139], v4, s[16:19], s36 offen offset:128
  buffer_load_dwordx4 v[140:143], v4, s[16:19], s36 offen offset:192
  s_add_u32 s36, s36, 4096
  v_lshrrev_b32 v5, 2, v3
  v_lshlrev_b32 v5, 3, v5
  v_and_b32 v6, 3, v3
  v_add_u32 v5, v5, v6
  v_lshlrev_b32 v5, 1, v5
  v_lshl_add_u32 v5, v2, 11, v5
  s_lshr_b32 s36, s35, 1
  s_lshl_b32 s36, s36, 6
  s_and_b32 s37, s35, 1
  s_lshl_b32 s37, s37, 3
  s_add_u32 s36, s36, s37
  s_add_u32 s37, s36, 0
  buffer_load_ushort v160, v5, s[20:23], s37 offen offset:0
  buffer_load_ushort v161, v5, s[20:23], s37 offen offset:256
  buffer_load_ushort v162, v5, s[20:23], s37 offen offset:512
  buffer_load_ushort v163, v5, s[20:23], s37 offen offset:768
  buffer_load_ushort v164, v5, s[20:23], s37 offen offset:1024
  buffer_load_ushort v165, v5, s[20:23], s37 offen offset:1280
  buffer_load_ushort v166, v5, s[20:23], s37 offen offset:1536
  buffer_load_ushort v167, v5, s[20:23], s37 offen offset:1792
  s_add_u32 s37, s36, 8192
  buffer_load_ushort v168, v5, s[20:23], s37 offen offset:0
  buffer_load_ushort v169, v5, s[20:23], s37 offen offset:256
  buffer_load_ushort v170, v5, s[20:23], s37 offen offset:512
  buffer_load_ushort v171, v5, s[20:23], s37 offen offset:768
  buffer_load_ushort v172, v5, s[20:23], s37 offen offset:1024
  buffer_load_ushort v173, v5, s[20:23], s37 offen offset:1280
  buffer_load_ushort v174, v5, s[20:23], s37 offen offset:1536
  buffer_load_ushort v175, v5, s[20:23], s37 offen offset:1792
  s_add_u32 s37, s36, 16384
  buffer_load_ushort v176, v5, s[20:23], s37 offen offset:0
  buffer_load_ushort v177, v5, s[20:23], s37 offen offset:256
  buffer_load_ushort v178, v5, s[20:23], s37 offen offset:512
  buffer_load_ushort v179, v5, s[20:23], s37 offen offset:768
  buffer_load_ushort v180, v5, s[20:23], s37 offen offset:1024
  buffer_load_ushort v181, v5, s[20:23], s37 offen offset:1280
  buffer_load_ushort v182, v5, s[20:23], s37 offen offset:1536
  buffer_load_ushort v183, v5, s[20:23], s37 offen offset:1792
  s_add_u32 s37, s36, 24576
  buffer_load_ushort v184, v5, s[20:23], s37 offen offset:0
  buffer_load_ushort v185, v5, s[20:23], s37 offen offset:256
  buffer_load_ushort v186, v5, s[20:23], s37 offen offset:512
  buffer_load_ushort v187, v5, s[20:23], s37 offen offset:768
  buffer_load_ushort v188, v5, s[20:23], s37 offen offset:1024
  buffer_load_ushort v189, v5, s[20:23], s37 offen offset:1280
  buffer_load_ushort v190, v5, s[20:23], s37 offen offset:1536
  buffer_load_ushort v191, v5, s[20:23], s37 offen offset:1792
  s_waitcnt vmcnt(30)
  v_lshl_or_b32 v144, v161, 16, v160
  s_waitcnt vmcnt(28)
  v_lshl_or_b32 v145, v163, 16, v162
  s_waitcnt vmcnt(26)
  v_lshl_or_b32 v146, v165, 16, v164
  s_waitcnt vmcnt(24)
  v_lshl_or_b32 v147, v167, 16, v166
  s_waitcnt vmcnt(22)
  v_lshl_or_b32 v148, v169, 16, v168
  s_waitcnt vmcnt(20)
  v_lshl_or_b32 v149, v171, 16, v170
  s_waitcnt vmcnt(18)
  v_lshl_or_b32 v150, v173, 16, v172
  s_waitcnt vmcnt(16)
  v_lshl_or_b32 v151, v175, 16, v174
  s_waitcnt vmcnt(14)
  v_lshl_or_b32 v152, v177, 16, v176
  s_waitcnt vmcnt(12)
  v_lshl_or_b32 v153, v179, 16, v178
  s_waitcnt vmcnt(10)
  v_lshl_or_b32 v154, v181, 16, v180
  s_waitcnt vmcnt(8)
  v_lshl_or_b32 v155, v183, 16, v182
  s_waitcnt vmcnt(6)
  v_lshl_or_b32 v156, v185, 16, v184
  s_waitcnt vmcnt(4)
  v_lshl_or_b32 v157, v187, 16, v186
  s_waitcnt vmcnt(2)
  v_lshl_or_b32 v158, v189, 16, v188
  s_waitcnt vmcnt(0)
  v_lshl_or_b32 v159, v191, 16, v190
  v_mfma_f32_16x16x32_bf16 v[160:163], v[16:19], v[144:147], 0
  v_mfma_f32_16x16x32_bf16 v[160:163], v[20:23], v[148:151], v[160:163]
  v_mfma_f32_16x16x32_bf16 v[160:163], v[24:27], v[152:155], v[160:163]
  v_mfma_f32_16x16x32_bf16 v[160:163], v[28:31], v[156:159], v[160:163]
  v_mfma_f32_16x16x32_bf16 v[164:167], v[32:35], v[144:147], 0
  v_mfma_f32_16x16x32_bf16 v[164:167], v[36:39], v[148:151], v[164:167]
  v_mfma_f32_16x16x32_bf16 v[164:167], v[40:43], v[152:155], v[164:167]
  v_mfma_f32_16x16x32_bf16 v[164:167], v[44:47], v[156:159], v[164:167]
  v_mfma_f32_16x16x32_bf16 v[168:171], v[48:51], v[144:147], 0
  v_mfma_f32_16x16x32_bf16 v[168:171], v[52:55], v[148:151], v[168:171]
  v_mfma_f32_16x16x32_bf16 v[168:171], v[56:59], v[152:155], v[168:171]
  v_mfma_f32_16x16x32_bf16 v[168:171], v[60:63], v[156:159], v[168:171]
  v_mfma_f32_16x16x32_bf16 v[172:175], v[64:67], v[144:147], 0
  v_mfma_f32_16x16x32_bf16 v[172:175], v[68:71], v[148:151], v[172:175]
  v_mfma_f32_16x16x32_bf16 v[172:175], v[72:75], v[152:155], v[172:175]
  v_mfma_f32_16x16x32_bf16 v[172:175], v[76:79], v[156:159], v[172:175]
  v_mfma_f32_16x16x32_bf16 v[176:179], v[80:83], v[144:147], 0
  v_mfma_f32_16x16x32_bf16 v[176:179], v[84:87], v[148:151], v[176:179]
  v_mfma_f32_16x16x32_bf16 v[176:179], v[88:91], v[152:155], v[176:179]
  v_mfma_f32_16x16x32_bf16 v[176:179], v[92:95], v[156:159], v[176:179]
  v_mfma_f32_16x16x32_bf16 v[180:183], v[96:99], v[144:147], 0
  v_mfma_f32_16x16x32_bf16 v[180:183], v[100:103], v[148:151], v[180:183]
  v_mfma_f32_16x16x32_bf16 v[180:183], v[104:107], v[152:155], v[180:183]
  v_mfma_f32_16x16x32_bf16 v[180:183], v[108:111], v[156:159], v[180:183]
  v_mfma_f32_16x16x32_bf16 v[184:187], v[112:115], v[144:147], 0
  v_mfma_f32_16x16x32_bf16 v[184:187], v[116:119], v[148:151], v[184:187]
  v_mfma_f32_16x16x32_bf16 v[184:187], v[120:123], v[152:155], v[184:187]
  v_mfma_f32_16x16x32_bf16 v[184:187], v[124:127], v[156:159], v[184:187]
  v_mfma_f32_16x16x32_bf16 v[188:191], v[128:131], v[144:147], 0
  v_mfma_f32_16x16x32_bf16 v[188:191], v[132:135], v[148:151], v[188:191]
  v_mfma_f32_16x16x32_bf16 v[188:191], v[136:139], v[152:155], v[188:191]
  v_mfma_f32_16x16x32_bf16 v[188:191], v[140:143], v[156:159], v[188:191]
  v_add_f32 v200, v160, v164
  v_add_f32 v201, v161, v165
  v_add_f32 v202, v162, v166
  v_add_f32 v203, v163, v167
  v_add_f32 v200, v200, v168
  v_add_f32 v201, v201, v169
  v_add_f32 v202, v202, v170
  v_add_f32 v203, v203, v171
  v_add_f32 v200, v200, v172
  v_add_f32 v201, v201, v173
  v_add_f32 v202, v202, v174
  v_add_f32 v203, v203, v175
  v_add_f32 v200, v200, v176
  v_add_f32 v201, v201, v177
  v_add_f32 v202, v202, v178
  v_add_f32 v203, v203, v179
  v_add_f32 v200, v200, v180
  v_add_f32 v201, v201, v181
  v_add_f32 v202, v202, v182
  v_add_f32 v203, v203, v183
  v_add_f32 v200, v200, v184
  v_add_f32 v201, v201, v185
  v_add_f32 v202, v202, v186
  v_add_f32 v203, v203, v187
  v_add_f32 v200, v200, v188
  v_add_f32 v201, v201, v189
  v_add_f32 v202, v202, v190
  v_add_f32 v203, v203, v191
  v_add_f32 v200, v200, v201
  v_add_f32 v202, v202, v203
  v_add_f32 v200, v200, v202
  v_mov_b32 v201, v200
  s_nop 1
  v_permlane16_swap_b32 v200, v201
  v_add_f32 v200, v200, v201
  v_mov_b32 v201, v200
  s_nop 1
  v_permlane32_swap_b32 v200, v201
  v_add_f32 v200, v200, v201
  v_mov_b32 v201, v191
  v_mov_b32 v202, v191
  s_nop 1
  v_permlane32_swap_b32 v201, v202
  v_mov_b32 v201, v202
  s_nop 1
  v_permlane16_swap_b32 v201, v202
  v_mul_f32 v202, 0x3dc69217, v202
  v_mul_f32 v200, 0xbc0c6921, v200
  v_add_f32 v200, v200, v202
  v_cmp_eq_u32 s[42:43], 3, v2
  v_add_f32 v160, v160, v200
  v_add_f32 v161, v161, v200
  v_add_f32 v162, v162, v200
  v_add_f32 v163, v163, v200
  v_add_f32 v164, v164, v200
  v_add_f32 v165, v165, v200
  v_add_f32 v166, v166, v200
  v_add_f32 v167, v167, v200
  v_add_f32 v168, v168, v200
  v_add_f32 v169, v169, v200
  v_add_f32 v170, v170, v200
  v_add_f32 v171, v171, v200
  v_add_f32 v172, v172, v200
  v_add_f32 v173, v173, v200
  v_add_f32 v174, v174, v200
  v_add_f32 v175, v175, v200
  v_add_f32 v176, v176, v200
  v_add_f32 v177, v177, v200
  v_add_f32 v178, v178, v200
  v_add_f32 v179, v179, v200
  v_add_f32 v180, v180, v200
  v_add_f32 v181, v181, v200
  v_add_f32 v182, v182, v200
  v_add_f32 v183, v183, v200
  v_add_f32 v184, v184, v200
  v_add_f32 v185, v185, v200
  v_add_f32 v186, v186, v200
  v_add_f32 v187, v187, v200
  v_add_f32 v188, v188, v200
  v_add_f32 v189, v189, v200
  v_add_f32 v190, v190, v200
  v_add_f32 v191, v191, v200
  v_cndmask_b32 v191, v191, 0, s[42:43]
  v_cvt_pk_bf16_f32 v16, v160, v161
  v_cvt_pk_bf16_f32 v17, v162, v163
  v_cvt_pk_bf16_f32 v18, v164, v165
  v_cvt_pk_bf16_f32 v19, v166, v167
  v_cvt_pk_bf16_f32 v20, v168, v169
  v_cvt_pk_bf16_f32 v21, v170, v171
  v_cvt_pk_bf16_f32 v22, v172, v173
  v_cvt_pk_bf16_f32 v23, v174, v175
  v_cvt_pk_bf16_f32 v24, v176, v177
  v_cvt_pk_bf16_f32 v25, v178, v179
  v_cvt_pk_bf16_f32 v26, v180, v181
  v_cvt_pk_bf16_f32 v27, v182, v183
  v_cvt_pk_bf16_f32 v28, v184, v185
  v_cvt_pk_bf16_f32 v29, v186, v187
  v_cvt_pk_bf16_f32 v30, v188, v189
  v_cvt_pk_bf16_f32 v31, v190, v191
  v_lshlrev_b32 v4, 4, v1
  s_lshl_b32 s36, s34, 12
  s_add_u32 s36, s36, 11665408
  buffer_store_dwordx4 v[16:19], v4, s[28:31], s36 offen offset:0 sc1
  buffer_store_dwordx4 v[20:23], v4, s[28:31], s36 offen offset:1024 sc1
  buffer_store_dwordx4 v[24:27], v4, s[28:31], s36 offen offset:2048 sc1
  buffer_store_dwordx4 v[28:31], v4, s[28:31], s36 offen offset:3072 sc1
  v_lshlrev_b32 v4, 26, v1
  v_mov_b32 v5, 1
  s_mov_b32 s36, 59782912
  s_waitcnt vmcnt(0)
  buffer_atomic_add v5, v4, s[28:31], s36 offen
  s_endpgm
Lk2_exit:
  s_endpgm
.section .rodata,"a"
.p2align 6
.amdhsa_kernel gps_prep_kernel
  .amdhsa_next_free_vgpr 256
  .amdhsa_next_free_sgpr 102
  .amdhsa_accum_offset 256
  .amdhsa_group_segment_fixed_size 0
  .amdhsa_kernarg_size 96
  .amdhsa_user_sgpr_count 2
  .amdhsa_user_sgpr_kernarg_segment_ptr 1
  .amdhsa_system_sgpr_workgroup_id_x 1
.end_amdhsa_kernel
.p2align 6
.amdhsa_kernel gps_attn_kernel
  .amdhsa_next_free_vgpr 512
  .amdhsa_next_free_sgpr 102
  .amdhsa_accum_offset 256
  .amdhsa_group_segment_fixed_size 0
  .amdhsa_kernarg_size 96
  .amdhsa_user_sgpr_count 2
  .amdhsa_user_sgpr_kernarg_segment_ptr 1
  .amdhsa_system_sgpr_workgroup_id_x 1
.end_amdhsa_kernel
```
